```python
import torch

def _softmax(x, axis=-1):
    return torch.softmax(x, dim=axis)
def _gelu(x):
    return torch.nn.functional.gelu(x, approximate="tanh")
def _silu(x):
    return torch.nn.functional.silu(x)
def _sigmoid(x):
    return torch.sigmoid(x)
def _layernorm(x, axis=-1, eps=1e-5):
    m = x.mean(dim=axis, keepdim=True)
    v = x.var(dim=axis, keepdim=True, unbiased=False)
    return (x - m) / torch.sqrt(v + eps)
def _scatter_add(tgt, idx, src, axis=0):
    return tgt.clone().index_add_(axis, idx, src)
def _segment_sum(src, seg, n):
    out = torch.zeros((n,) + src.shape[1:], dtype=src.dtype)
    return out.index_add_(0, seg, src)
def _pad(x, pw):
    flat = tuple(v for pair in reversed(pw) for v in pair)
    return torch.nn.functional.pad(x, flat)

kernel_name = 'sequential_preLN__linear_attn_block__dense_activation_silu__prompt'

def setup_inputs():

    _w = (lambda a: (lambda t: t.to(torch.bfloat16) if t.is_floating_point() else t)(torch.as_tensor(a)))
    def _A_setup():
        B, S, D = 1, 2048, 640
        return {
            "x": _w((lambda *s: torch.randn(*s, dtype=torch.bfloat16) * 0.05)(B, S, D)),
            "wqkv": _w((lambda *s: torch.randn(*s, dtype=torch.bfloat16) * 0.05)(D, 3 * D)),
            "wo": _w((lambda *s: torch.randn(*s, dtype=torch.bfloat16) * 0.05)(D, D)),
        }
    _A_in = _A_setup()

    def _B_setup():
        B, S, D, F = 1, 2048, 640, 1728
        return {
            "x": _w((lambda *s: torch.randn(*s, dtype=torch.bfloat16) * 0.05)(B, S, D)),
            "w1": _w((lambda *s: torch.randn(*s, dtype=torch.bfloat16) * 0.8)(D, F) * (D ** -0.5)),
            "w2": _w((lambda *s: torch.randn(*s, dtype=torch.bfloat16) * 0.1)(F, D) * (F ** -0.5)),
        }
    _B_in = _B_setup()

    return {
        "A_x": _A_in["x"],
        "A_wqkv": _A_in["wqkv"],
        "A_wo": _A_in["wo"],
        "B_x": _B_in["x"],
        "B_w1": _B_in["w1"],
        "B_w2": _B_in["w2"],
    }

def reference(A_x, A_wqkv, A_wo, B_x, B_w1, B_w2):
    def _A_ref(x, wqkv, wo):
        B, S, D = x.shape
        H = 32; Dh = D // H
        qkv = (lambda x, *d: x.permute(*d))((x @ wqkv).reshape(B, S, 3, H, Dh), 2, 0, 3, 1, 4)
        q, k, v = qkv[0], qkv[1], qkv[2]
        phi = lambda t: torch.where(t > 0, t + 1, torch.exp(t)) + 1e-6
        pq, pk = phi(q), phi(k)
        kv = torch.einsum("bhsd,bhse->bhde", pk, v)
        z = torch.einsum("bhsd->bhd", pk)
        num = torch.einsum("bhqd,bhde->bhqe", pq, kv)
        den = torch.einsum("bhqd,bhd->bhq", pq, z)[..., None] + 1e-6
        o = num / den
        return (lambda x, *d: x.permute(*d))(o, 0, 2, 1, 3).reshape(B, S, D) @ wo

    def _B_ref(x, w1, w2):
        h = torch.einsum("bsd,df->bsf", x, w1)
        h = _silu(h)
        out = torch.einsum("bsf,fd->bsd", h, w2)
        return out

    x = A_x
    h = x + _A_ref(_layernorm(x, axis=-1), A_wqkv, A_wo)
    h2 = h + _B_ref(_layernorm(h, axis=-1), B_w1, B_w2)
    return h2
```

```asm
; @launch kernel=k1_qkv_kernel grid=(256,1,1) block=(768,1,1) lds=163840
; @launch kernel=k2_attn_kernel grid=(256,1,1) block=(512,1,1) lds=163840
; @launch kernel=k3_ffn1_kernel grid=(256,1,1) block=(768,1,1) lds=163840
; @launch kernel=k4_ffn2_kernel grid=(256,1,1) block=(768,1,1) lds=147456
.amdgcn_target "amdgcn-amd-amdhsa--gfx950"
.text
.globl k1_qkv_kernel
.p2align 8
.type k1_qkv_kernel,@function
k1_qkv_kernel:
  s_cmp_ge_u32 s2, 256
  s_cbranch_scc1 L1_done
  s_load_dwordx2 s[4:5], s[0:1], 0
  s_load_dwordx2 s[6:7], s[0:1], 8
  s_load_dwordx4 s[36:39], s[0:1], 56
  s_and_b32 s40, s2, 7
  s_lshr_b32 s41, s2, 3
  s_lshr_b32 s24, s40, 1
  s_lshl_b32 s24, s24, 2
  s_and_b32 s42, s41, 3
  s_add_u32 s24, s24, s42
  s_and_b32 s25, s40, 1
  s_lshl_b32 s25, s25, 3
  s_lshr_b32 s42, s41, 2
  s_add_u32 s25, s25, s42
  v_lshrrev_b32 v1, 6, v0
  v_and_b32 v0, 63, v0
  v_readfirstlane_b32 s26, v1
  s_waitcnt lgkmcnt(0)
  s_mov_b32 s8, s4
  s_mov_b32 s9, s5
  s_mov_b32 s10, 2621440
  s_mov_b32 s11, 0x00020000
  s_mov_b32 s12, s6
  s_mov_b32 s13, s7
  s_mov_b32 s14, 2457600
  s_mov_b32 s15, 0x00020000
  s_mov_b32 s16, s38
  s_mov_b32 s17, s39
  s_mov_b32 s18, 21053440
  s_mov_b32 s19, 0x00020000
  s_mov_b32 s20, s36
  s_mov_b32 s21, s37
  s_mov_b32 s22, 256
  s_mov_b32 s23, 0x00020000
  s_cmp_ge_u32 s26, 4
  s_cbranch_scc1 L1_loader
  s_lshr_b32 s27, s26, 1
  s_and_b32 s28, s26, 1
  v_and_b32 v8, 15, v0
  v_lshrrev_b32 v9, 4, v0
  v_and_b32 v10, 7, v8
  v_xor_b32 v10, v10, v9
  v_lshlrev_b32 v10, 4, v10
  v_lshl_add_u32 v10, v8, 7, v10
  s_lshl_b32 s40, s27, 13
  v_add_u32 v2, s40, v10
  v_xor_b32 v3, 64, v2
  v_lshrrev_b32 v10, 2, v8
  v_and_b32 v11, 1, v9
  v_lshl_add_u32 v11, v11, 2, v10
  v_lshl_add_u32 v10, v9, 3, v10
  v_lshlrev_b32 v10, 8, v10
  v_add_u32 v10, 16384, v10
  v_and_b32 v12, 3, v8
  s_mul_i32 s40, s28, 5
  v_add_u32 v144, s40, v12
  v_lshrrev_b32 v145, 2, v144
  v_xor_b32 v145, v145, v11
  v_lshl_add_u32 v145, v145, 5, v10
  v_and_b32 v144, 3, v144
  v_lshl_add_u32 v4, v144, 3, v145
  s_mul_i32 s40, s28, 5
  s_add_u32 s40, s40, 10
  v_add_u32 v144, s40, v12
  v_lshrrev_b32 v145, 2, v144
  v_xor_b32 v145, v145, v11
  v_lshl_add_u32 v145, v145, 5, v10
  v_and_b32 v144, 3, v144
  v_lshl_add_u32 v5, v144, 3, v145
  s_mul_i32 s40, s28, 5
  v_mul_u32_u24 v144, 10, v12
  s_add_u32 s40, s40, 4
  v_add_u32 v144, s40, v144
  v_add_u32 v145, 26, v12
  v_cmp_gt_u32 vcc, 2, v12
  s_nop 1
  v_cndmask_b32 v144, v145, v144, vcc
  v_lshrrev_b32 v145, 2, v144
  v_xor_b32 v145, v145, v11
  v_lshl_add_u32 v145, v145, 5, v10
  v_and_b32 v144, 3, v144
  v_lshl_add_u32 v6, v144, 3, v145
  s_mul_i32 s40, s28, 5
  s_lshl_b32 s40, s28, 2
  s_add_u32 s40, s40, 20
  v_add_u32 v144, s40, v12
  v_lshrrev_b32 v145, 2, v144
  v_xor_b32 v145, v145, v11
  v_lshl_add_u32 v145, v145, 5, v10
  v_and_b32 v144, 3, v144
  v_lshl_add_u32 v7, v144, 3, v145
  v_mov_b32 v80, 0
  v_mov_b32 v81, 0
  v_mov_b32 v82, 0
  v_mov_b32 v83, 0
  v_mov_b32 v84, 0
  v_mov_b32 v85, 0
  v_mov_b32 v86, 0
  v_mov_b32 v87, 0
  v_mov_b32 v88, 0
  v_mov_b32 v89, 0
  v_mov_b32 v90, 0
  v_mov_b32 v91, 0
  v_mov_b32 v92, 0
  v_mov_b32 v93, 0
  v_mov_b32 v94, 0
  v_mov_b32 v95, 0
  v_mov_b32 v96, 0
  v_mov_b32 v97, 0
  v_mov_b32 v98, 0
  v_mov_b32 v99, 0
  v_mov_b32 v100, 0
  v_mov_b32 v101, 0
  v_mov_b32 v102, 0
  v_mov_b32 v103, 0
  v_mov_b32 v104, 0
  v_mov_b32 v105, 0
  v_mov_b32 v106, 0
  v_mov_b32 v107, 0
  v_mov_b32 v108, 0
  v_mov_b32 v109, 0
  v_mov_b32 v110, 0
  v_mov_b32 v111, 0
  v_mov_b32 v112, 0
  v_mov_b32 v113, 0
  v_mov_b32 v114, 0
  v_mov_b32 v115, 0
  v_mov_b32 v116, 0
  v_mov_b32 v117, 0
  v_mov_b32 v118, 0
  v_mov_b32 v119, 0
  v_mov_b32 v120, 0
  v_mov_b32 v121, 0
  v_mov_b32 v122, 0
  v_mov_b32 v123, 0
  v_mov_b32 v124, 0
  v_mov_b32 v125, 0
  v_mov_b32 v126, 0
  v_mov_b32 v127, 0
  v_mov_b32 v128, 0
  v_mov_b32 v129, 0
  v_mov_b32 v130, 0
  v_mov_b32 v131, 0
  v_mov_b32 v132, 0
  v_mov_b32 v133, 0
  v_mov_b32 v134, 0
  v_mov_b32 v135, 0
  v_mov_b32 v136, 0
  v_mov_b32 v137, 0
  v_mov_b32 v138, 0
  v_mov_b32 v139, 0
  v_mov_b32 v140, 0
  v_mov_b32 v141, 0
  v_mov_b32 v142, 0
  v_mov_b32 v143, 0
  s_mov_b32 s52, 32768
  v_lshl_or_b32 v11, s26, 6, v0
  v_mov_b32 v144, 0
  v_mov_b32 v145, 0
  v_mov_b32 v146, 0
  v_mov_b32 v147, 0
  v_lshlrev_b32 v12, 4, v11
  v_add_u32 v10, 135168, v12
  ds_write_b128 v10, v[144:147]
  s_cmp_ge_u32 s2, 16
  s_cbranch_scc1 L1_nozero
  s_mul_i32 s40, s2, 3360
  s_add_u32 s40, s40, 2621440
  v_cmp_gt_u32 vcc, 210, v11
  s_and_saveexec_b64 s[46:47], vcc
  buffer_store_dwordx4 v[144:147], v12, s[16:19], s40 offen sc0 sc1
  s_mov_b64 exec, s[46:47]
  s_waitcnt vmcnt(0)
  s_lshl_b32 s40, s2, 2
  v_mov_b32 v10, s40
  v_mov_b32 v12, 1
  s_mov_b64 exec, 1
  buffer_atomic_add v12, v10, s[20:23], 0 offen sc1
  s_mov_b64 exec, -1
L1_nozero:
  s_waitcnt lgkmcnt(0)
  s_barrier
  ds_read_b128 v[16:19], v2 offset:0
  ds_read_b128 v[20:23], v2 offset:2048
  ds_read_b128 v[24:27], v2 offset:4096
  ds_read_b128 v[28:31], v2 offset:6144
  ds_read_b64_tr_b16 v[32:33], v4 offset:0
  ds_read_b64_tr_b16 v[34:35], v4 offset:1024
  ds_read_b64_tr_b16 v[36:37], v5 offset:0
  ds_read_b64_tr_b16 v[38:39], v5 offset:1024
  ds_read_b64_tr_b16 v[40:41], v6 offset:0
  ds_read_b64_tr_b16 v[42:43], v6 offset:1024
  ds_read_b64_tr_b16 v[44:45], v7 offset:0
  ds_read_b64_tr_b16 v[46:47], v7 offset:1024
  s_mov_b32 s29, 0
  s_mov_b32 s30, 0
  v_mov_b32 v144, 0
  v_mov_b32 v145, 0
  v_mov_b32 v146, 0
  v_mov_b32 v147, 0
  v_mov_b32 v148, 0
  v_mov_b32 v149, 0
  v_mov_b32 v150, 0
  v_mov_b32 v151, 0
  v_mov_b32 v152, 0
  v_mov_b32 v153, 0
  v_mov_b32 v154, 0
  v_mov_b32 v155, 0
  v_mov_b32 v156, 0
  v_mov_b32 v157, 0
  v_mov_b32 v158, 0
  v_mov_b32 v159, 0
  v_mov_b32 v160, 0x3f803f80
  v_mov_b32 v161, 0x3f803f80
  v_mov_b32 v162, 0x3f803f80
  v_mov_b32 v163, 0x3f803f80
  v_and_b32 v8, 15, v0
  v_cmp_lt_u32 s[48:49], 7, v8
  s_cmp_eq_u32 s26, 1
  s_cbranch_scc1 L1_loop1
  s_cmp_eq_u32 s26, 2
  s_cbranch_scc1 L1_loop2
  s_cmp_eq_u32 s26, 3
  s_cbranch_scc1 L1_loop3
L1_loop0:
  s_add_u32 s30, s30, 32768
  s_cmp_eq_u32 s30, 131072
  s_cselect_b32 s40, -98304, s52
  s_cselect_b32 s30, 0, s30
  s_waitcnt lgkmcnt(0)
  v_mfma_f32_16x16x32_bf16 v[80:83], v[16:19], v[32:35], v[80:83]
  ds_read_b128 v[48:51], v3 offset:0
  v_mfma_f32_16x16x32_bf16 v[84:87], v[16:19], v[36:39], v[84:87]
  ds_read_b128 v[52:55], v3 offset:2048
  v_mfma_f32_16x16x32_bf16 v[88:91], v[16:19], v[40:43], v[88:91]
  ds_read_b128 v[56:59], v3 offset:4096
  v_mfma_f32_16x16x32_bf16 v[92:95], v[44:47], v[16:19], v[92:95]
  ds_read_b128 v[60:63], v3 offset:6144
  v_mfma_f32_16x16x32_bf16 v[96:99], v[20:23], v[32:35], v[96:99]
  ds_read_b64_tr_b16 v[64:65], v4 offset:8192
  v_mfma_f32_16x16x32_bf16 v[100:103], v[20:23], v[36:39], v[100:103]
  ds_read_b64_tr_b16 v[66:67], v4 offset:9216
  v_mfma_f32_16x16x32_bf16 v[104:107], v[20:23], v[40:43], v[104:107]
  ds_read_b64_tr_b16 v[68:69], v5 offset:8192
  v_mfma_f32_16x16x32_bf16 v[108:111], v[44:47], v[20:23], v[108:111]
  ds_read_b64_tr_b16 v[70:71], v5 offset:9216
  v_mfma_f32_16x16x32_bf16 v[144:147], v[16:19], v[16:19], v[144:147]
  ds_read_b64_tr_b16 v[72:73], v6 offset:8192
  v_mfma_f32_16x16x32_bf16 v[148:151], v[20:23], v[20:23], v[148:151]
  ds_read_b64_tr_b16 v[74:75], v6 offset:9216
  v_mfma_f32_16x16x32_bf16 v[112:115], v[24:27], v[32:35], v[112:115]
  ds_read_b64_tr_b16 v[76:77], v7 offset:8192
  v_mfma_f32_16x16x32_bf16 v[116:119], v[24:27], v[36:39], v[116:119]
  ds_read_b64_tr_b16 v[78:79], v7 offset:9216
  v_mfma_f32_16x16x32_bf16 v[120:123], v[24:27], v[40:43], v[120:123]
  v_add_u32 v2, s40, v2
  v_mfma_f32_16x16x32_bf16 v[124:127], v[44:47], v[24:27], v[124:127]
  v_add_u32 v3, s40, v3
  v_mfma_f32_16x16x32_bf16 v[128:131], v[28:31], v[32:35], v[128:131]
  v_add_u32 v4, s40, v4
  v_mfma_f32_16x16x32_bf16 v[132:135], v[28:31], v[36:39], v[132:135]
  v_add_u32 v5, s40, v5
  v_mfma_f32_16x16x32_bf16 v[136:139], v[28:31], v[40:43], v[136:139]
  v_add_u32 v6, s40, v6
  v_mfma_f32_16x16x32_bf16 v[140:143], v[44:47], v[28:31], v[140:143]
  v_add_u32 v7, s40, v7
  v_mfma_f32_16x16x32_bf16 v[152:155], v[160:163], v[32:35], v[152:155]
  v_mfma_f32_16x16x32_bf16 v[156:159], v[160:163], v[36:39], v[156:159]
  s_cmp_eq_u32 s29, 9
  s_cbranch_scc1 L1_last0
  s_add_u32 s29, s29, 1
  s_waitcnt lgkmcnt(0)
  s_barrier
  v_mfma_f32_16x16x32_bf16 v[80:83], v[48:51], v[64:67], v[80:83]
  ds_read_b128 v[16:19], v2 offset:0
  v_mfma_f32_16x16x32_bf16 v[84:87], v[48:51], v[68:71], v[84:87]
  ds_read_b128 v[20:23], v2 offset:2048
  v_mfma_f32_16x16x32_bf16 v[88:91], v[48:51], v[72:75], v[88:91]
  ds_read_b128 v[24:27], v2 offset:4096
  v_mfma_f32_16x16x32_bf16 v[92:95], v[76:79], v[48:51], v[92:95]
  ds_read_b128 v[28:31], v2 offset:6144
  v_mfma_f32_16x16x32_bf16 v[96:99], v[52:55], v[64:67], v[96:99]
  ds_read_b64_tr_b16 v[32:33], v4 offset:0
  v_mfma_f32_16x16x32_bf16 v[100:103], v[52:55], v[68:71], v[100:103]
  ds_read_b64_tr_b16 v[34:35], v4 offset:1024
  v_mfma_f32_16x16x32_bf16 v[104:107], v[52:55], v[72:75], v[104:107]
  ds_read_b64_tr_b16 v[36:37], v5 offset:0
  v_mfma_f32_16x16x32_bf16 v[108:111], v[76:79], v[52:55], v[108:111]
  ds_read_b64_tr_b16 v[38:39], v5 offset:1024
  v_mfma_f32_16x16x32_bf16 v[144:147], v[48:51], v[48:51], v[144:147]
  ds_read_b64_tr_b16 v[40:41], v6 offset:0
  v_mfma_f32_16x16x32_bf16 v[148:151], v[52:55], v[52:55], v[148:151]
  ds_read_b64_tr_b16 v[42:43], v6 offset:1024
  v_mfma_f32_16x16x32_bf16 v[112:115], v[56:59], v[64:67], v[112:115]
  ds_read_b64_tr_b16 v[44:45], v7 offset:0
  v_mfma_f32_16x16x32_bf16 v[116:119], v[56:59], v[68:71], v[116:119]
  ds_read_b64_tr_b16 v[46:47], v7 offset:1024
  v_mfma_f32_16x16x32_bf16 v[120:123], v[56:59], v[72:75], v[120:123]
  v_mfma_f32_16x16x32_bf16 v[124:127], v[76:79], v[56:59], v[124:127]
  v_mfma_f32_16x16x32_bf16 v[128:131], v[60:63], v[64:67], v[128:131]
  v_mfma_f32_16x16x32_bf16 v[132:135], v[60:63], v[68:71], v[132:135]
  v_mfma_f32_16x16x32_bf16 v[136:139], v[60:63], v[72:75], v[136:139]
  v_mfma_f32_16x16x32_bf16 v[140:143], v[76:79], v[60:63], v[140:143]
  v_mfma_f32_16x16x32_bf16 v[152:155], v[160:163], v[64:67], v[152:155]
  v_mfma_f32_16x16x32_bf16 v[156:159], v[160:163], v[68:71], v[156:159]
  s_branch L1_loop0
L1_last0:
  s_waitcnt lgkmcnt(0)
  v_mfma_f32_16x16x32_bf16 v[80:83], v[48:51], v[64:67], v[80:83]
  v_mfma_f32_16x16x32_bf16 v[84:87], v[48:51], v[68:71], v[84:87]
  v_mfma_f32_16x16x32_bf16 v[88:91], v[48:51], v[72:75], v[88:91]
  v_mfma_f32_16x16x32_bf16 v[92:95], v[76:79], v[48:51], v[92:95]
  v_mfma_f32_16x16x32_bf16 v[96:99], v[52:55], v[64:67], v[96:99]
  v_mfma_f32_16x16x32_bf16 v[100:103], v[52:55], v[68:71], v[100:103]
  v_mfma_f32_16x16x32_bf16 v[104:107], v[52:55], v[72:75], v[104:107]
  v_mfma_f32_16x16x32_bf16 v[108:111], v[76:79], v[52:55], v[108:111]
  v_mfma_f32_16x16x32_bf16 v[144:147], v[48:51], v[48:51], v[144:147]
  v_mfma_f32_16x16x32_bf16 v[148:151], v[52:55], v[52:55], v[148:151]
  v_mfma_f32_16x16x32_bf16 v[112:115], v[56:59], v[64:67], v[112:115]
  v_mfma_f32_16x16x32_bf16 v[116:119], v[56:59], v[68:71], v[116:119]
  v_mfma_f32_16x16x32_bf16 v[120:123], v[56:59], v[72:75], v[120:123]
  v_mfma_f32_16x16x32_bf16 v[124:127], v[76:79], v[56:59], v[124:127]
  v_mfma_f32_16x16x32_bf16 v[128:131], v[60:63], v[64:67], v[128:131]
  v_mfma_f32_16x16x32_bf16 v[132:135], v[60:63], v[68:71], v[132:135]
  v_mfma_f32_16x16x32_bf16 v[136:139], v[60:63], v[72:75], v[136:139]
  v_mfma_f32_16x16x32_bf16 v[140:143], v[76:79], v[60:63], v[140:143]
  v_mfma_f32_16x16x32_bf16 v[152:155], v[160:163], v[64:67], v[152:155]
  v_mfma_f32_16x16x32_bf16 v[156:159], v[160:163], v[68:71], v[156:159]
  v_lshrrev_b32 v9, 4, v0
  v_lshrrev_b32 v10, 2, v8
  v_cmp_eq_u32 s[50:51], v9, v10
  v_and_b32 v10, 3, v8
  s_nop 7
  v_mov_b32 v11, v144
  v_cmp_eq_u32 vcc, 1, v10
  s_nop 1
  v_cndmask_b32 v11, v11, v145, vcc
  v_cmp_eq_u32 vcc, 2, v10
  s_nop 1
  v_cndmask_b32 v11, v11, v146, vcc
  v_cmp_eq_u32 vcc, 3, v10
  s_nop 1
  v_cndmask_b32 v11, v11, v147, vcc
  v_lshlrev_b32 v12, 2, v8
  v_add_u32 v12, 131584, v12
  s_mov_b64 exec, s[50:51]
  ds_write_b32 v12, v11
  s_mov_b64 exec, -1
  v_mov_b32 v11, v148
  v_cmp_eq_u32 vcc, 1, v10
  s_nop 1
  v_cndmask_b32 v11, v11, v149, vcc
  v_cmp_eq_u32 vcc, 2, v10
  s_nop 1
  v_cndmask_b32 v11, v11, v150, vcc
  v_cmp_eq_u32 vcc, 3, v10
  s_nop 1
  v_cndmask_b32 v11, v11, v151, vcc
  v_lshlrev_b32 v12, 2, v8
  v_add_u32 v12, 131648, v12
  s_mov_b64 exec, s[50:51]
  ds_write_b32 v12, v11
  s_mov_b64 exec, -1
  v_lshlrev_b32 v12, 2, v8
  v_add_u32 v12, 132096, v12
  s_mov_b64 exec, 0xffff
  ds_write_b32 v12, v152
  s_mov_b64 exec, -1
  v_lshlrev_b32 v12, 2, v8
  v_add_u32 v12, 132256, v12
  s_mov_b64 exec, 0xffff
  ds_write_b32 v12, v156
  s_mov_b64 exec, -1
  s_branch L1_fins
L1_loop1:
  s_add_u32 s30, s30, 32768
  s_cmp_eq_u32 s30, 131072
  s_cselect_b32 s40, -98304, s52
  s_cselect_b32 s30, 0, s30
  s_waitcnt lgkmcnt(0)
  v_cndmask_b32 v40, v40, v160, s[48:49]
  ds_read_b128 v[48:51], v3 offset:0
  v_cndmask_b32 v41, v41, v160, s[48:49]
  ds_read_b128 v[52:55], v3 offset:2048
  v_cndmask_b32 v42, v42, v160, s[48:49]
  ds_read_b128 v[56:59], v3 offset:4096
  v_cndmask_b32 v43, v43, v160, s[48:49]
  ds_read_b128 v[60:63], v3 offset:6144
  v_mfma_f32_16x16x32_bf16 v[80:83], v[16:19], v[32:35], v[80:83]
  ds_read_b64_tr_b16 v[64:65], v4 offset:8192
  v_mfma_f32_16x16x32_bf16 v[84:87], v[16:19], v[36:39], v[84:87]
  ds_read_b64_tr_b16 v[66:67], v4 offset:9216
  v_mfma_f32_16x16x32_bf16 v[88:91], v[16:19], v[40:43], v[88:91]
  ds_read_b64_tr_b16 v[68:69], v5 offset:8192
  v_mfma_f32_16x16x32_bf16 v[92:95], v[44:47], v[16:19], v[92:95]
  ds_read_b64_tr_b16 v[70:71], v5 offset:9216
  v_mfma_f32_16x16x32_bf16 v[96:99], v[20:23], v[32:35], v[96:99]
  ds_read_b64_tr_b16 v[72:73], v6 offset:8192
  v_mfma_f32_16x16x32_bf16 v[100:103], v[20:23], v[36:39], v[100:103]
  ds_read_b64_tr_b16 v[74:75], v6 offset:9216
  v_mfma_f32_16x16x32_bf16 v[104:107], v[20:23], v[40:43], v[104:107]
  ds_read_b64_tr_b16 v[76:77], v7 offset:8192
  v_mfma_f32_16x16x32_bf16 v[108:111], v[44:47], v[20:23], v[108:111]
  ds_read_b64_tr_b16 v[78:79], v7 offset:9216
  v_mfma_f32_16x16x32_bf16 v[144:147], v[24:27], v[24:27], v[144:147]
  v_add_u32 v2, s40, v2
  v_mfma_f32_16x16x32_bf16 v[148:151], v[28:31], v[28:31], v[148:151]
  v_add_u32 v3, s40, v3
  v_mfma_f32_16x16x32_bf16 v[112:115], v[24:27], v[32:35], v[112:115]
  v_add_u32 v4, s40, v4
  v_mfma_f32_16x16x32_bf16 v[116:119], v[24:27], v[36:39], v[116:119]
  v_add_u32 v5, s40, v5
  v_mfma_f32_16x16x32_bf16 v[120:123], v[24:27], v[40:43], v[120:123]
  v_add_u32 v6, s40, v6
  v_mfma_f32_16x16x32_bf16 v[124:127], v[44:47], v[24:27], v[124:127]
  v_add_u32 v7, s40, v7
  v_mfma_f32_16x16x32_bf16 v[128:131], v[28:31], v[32:35], v[128:131]
  v_mfma_f32_16x16x32_bf16 v[132:135], v[28:31], v[36:39], v[132:135]
  v_mfma_f32_16x16x32_bf16 v[136:139], v[28:31], v[40:43], v[136:139]
  v_mfma_f32_16x16x32_bf16 v[140:143], v[44:47], v[28:31], v[140:143]
  v_mfma_f32_16x16x32_bf16 v[152:155], v[160:163], v[32:35], v[152:155]
  v_mfma_f32_16x16x32_bf16 v[156:159], v[160:163], v[36:39], v[156:159]
  s_cmp_eq_u32 s29, 9
  s_cbranch_scc1 L1_last1
  s_add_u32 s29, s29, 1
  s_waitcnt lgkmcnt(0)
  s_barrier
  v_cndmask_b32 v72, v72, v160, s[48:49]
  ds_read_b128 v[16:19], v2 offset:0
  v_cndmask_b32 v73, v73, v160, s[48:49]
  ds_read_b128 v[20:23], v2 offset:2048
  v_cndmask_b32 v74, v74, v160, s[48:49]
  ds_read_b128 v[24:27], v2 offset:4096
  v_cndmask_b32 v75, v75, v160, s[48:49]
  ds_read_b128 v[28:31], v2 offset:6144
  v_mfma_f32_16x16x32_bf16 v[80:83], v[48:51], v[64:67], v[80:83]
  ds_read_b64_tr_b16 v[32:33], v4 offset:0
  v_mfma_f32_16x16x32_bf16 v[84:87], v[48:51], v[68:71], v[84:87]
  ds_read_b64_tr_b16 v[34:35], v4 offset:1024
  v_mfma_f32_16x16x32_bf16 v[88:91], v[48:51], v[72:75], v[88:91]
  ds_read_b64_tr_b16 v[36:37], v5 offset:0
  v_mfma_f32_16x16x32_bf16 v[92:95], v[76:79], v[48:51], v[92:95]
  ds_read_b64_tr_b16 v[38:39], v5 offset:1024
  v_mfma_f32_16x16x32_bf16 v[96:99], v[52:55], v[64:67], v[96:99]
  ds_read_b64_tr_b16 v[40:41], v6 offset:0
  v_mfma_f32_16x16x32_bf16 v[100:103], v[52:55], v[68:71], v[100:103]
  ds_read_b64_tr_b16 v[42:43], v6 offset:1024
  v_mfma_f32_16x16x32_bf16 v[104:107], v[52:55], v[72:75], v[104:107]
  ds_read_b64_tr_b16 v[44:45], v7 offset:0
  v_mfma_f32_16x16x32_bf16 v[108:111], v[76:79], v[52:55], v[108:111]
  ds_read_b64_tr_b16 v[46:47], v7 offset:1024
  v_mfma_f32_16x16x32_bf16 v[144:147], v[56:59], v[56:59], v[144:147]
  v_mfma_f32_16x16x32_bf16 v[148:151], v[60:63], v[60:63], v[148:151]
  v_mfma_f32_16x16x32_bf16 v[112:115], v[56:59], v[64:67], v[112:115]
  v_mfma_f32_16x16x32_bf16 v[116:119], v[56:59], v[68:71], v[116:119]
  v_mfma_f32_16x16x32_bf16 v[120:123], v[56:59], v[72:75], v[120:123]
  v_mfma_f32_16x16x32_bf16 v[124:127], v[76:79], v[56:59], v[124:127]
  v_mfma_f32_16x16x32_bf16 v[128:131], v[60:63], v[64:67], v[128:131]
  v_mfma_f32_16x16x32_bf16 v[132:135], v[60:63], v[68:71], v[132:135]
  v_mfma_f32_16x16x32_bf16 v[136:139], v[60:63], v[72:75], v[136:139]
  v_mfma_f32_16x16x32_bf16 v[140:143], v[76:79], v[60:63], v[140:143]
  v_mfma_f32_16x16x32_bf16 v[152:155], v[160:163], v[64:67], v[152:155]
  v_mfma_f32_16x16x32_bf16 v[156:159], v[160:163], v[68:71], v[156:159]
  s_branch L1_loop1
L1_last1:
  s_waitcnt lgkmcnt(0)
  v_cndmask_b32 v72, v72, v160, s[48:49]
  v_cndmask_b32 v73, v73, v160, s[48:49]
  v_cndmask_b32 v74, v74, v160, s[48:49]
  v_cndmask_b32 v75, v75, v160, s[48:49]
  v_mfma_f32_16x16x32_bf16 v[80:83], v[48:51], v[64:67], v[80:83]
  v_mfma_f32_16x16x32_bf16 v[84:87], v[48:51], v[68:71], v[84:87]
  v_mfma_f32_16x16x32_bf16 v[88:91], v[48:51], v[72:75], v[88:91]
  v_mfma_f32_16x16x32_bf16 v[92:95], v[76:79], v[48:51], v[92:95]
  v_mfma_f32_16x16x32_bf16 v[96:99], v[52:55], v[64:67], v[96:99]
  v_mfma_f32_16x16x32_bf16 v[100:103], v[52:55], v[68:71], v[100:103]
  v_mfma_f32_16x16x32_bf16 v[104:107], v[52:55], v[72:75], v[104:107]
  v_mfma_f32_16x16x32_bf16 v[108:111], v[76:79], v[52:55], v[108:111]
  v_mfma_f32_16x16x32_bf16 v[144:147], v[56:59], v[56:59], v[144:147]
  v_mfma_f32_16x16x32_bf16 v[148:151], v[60:63], v[60:63], v[148:151]
  v_mfma_f32_16x16x32_bf16 v[112:115], v[56:59], v[64:67], v[112:115]
  v_mfma_f32_16x16x32_bf16 v[116:119], v[56:59], v[68:71], v[116:119]
  v_mfma_f32_16x16x32_bf16 v[120:123], v[56:59], v[72:75], v[120:123]
  v_mfma_f32_16x16x32_bf16 v[124:127], v[76:79], v[56:59], v[124:127]
  v_mfma_f32_16x16x32_bf16 v[128:131], v[60:63], v[64:67], v[128:131]
  v_mfma_f32_16x16x32_bf16 v[132:135], v[60:63], v[68:71], v[132:135]
  v_mfma_f32_16x16x32_bf16 v[136:139], v[60:63], v[72:75], v[136:139]
  v_mfma_f32_16x16x32_bf16 v[140:143], v[76:79], v[60:63], v[140:143]
  v_mfma_f32_16x16x32_bf16 v[152:155], v[160:163], v[64:67], v[152:155]
  v_mfma_f32_16x16x32_bf16 v[156:159], v[160:163], v[68:71], v[156:159]
  v_lshrrev_b32 v9, 4, v0
  v_lshrrev_b32 v10, 2, v8
  v_cmp_eq_u32 s[50:51], v9, v10
  v_and_b32 v10, 3, v8
  s_nop 7
  v_mov_b32 v11, v144
  v_cmp_eq_u32 vcc, 1, v10
  s_nop 1
  v_cndmask_b32 v11, v11, v145, vcc
  v_cmp_eq_u32 vcc, 2, v10
  s_nop 1
  v_cndmask_b32 v11, v11, v146, vcc
  v_cmp_eq_u32 vcc, 3, v10
  s_nop 1
  v_cndmask_b32 v11, v11, v147, vcc
  v_lshlrev_b32 v12, 2, v8
  v_add_u32 v12, 131712, v12
  s_mov_b64 exec, s[50:51]
  ds_write_b32 v12, v11
  s_mov_b64 exec, -1
  v_mov_b32 v11, v148
  v_cmp_eq_u32 vcc, 1, v10
  s_nop 1
  v_cndmask_b32 v11, v11, v149, vcc
  v_cmp_eq_u32 vcc, 2, v10
  s_nop 1
  v_cndmask_b32 v11, v11, v150, vcc
  v_cmp_eq_u32 vcc, 3, v10
  s_nop 1
  v_cndmask_b32 v11, v11, v151, vcc
  v_lshlrev_b32 v12, 2, v8
  v_add_u32 v12, 131776, v12
  s_mov_b64 exec, s[50:51]
  ds_write_b32 v12, v11
  s_mov_b64 exec, -1
  v_lshlrev_b32 v12, 2, v8
  v_add_u32 v12, 132176, v12
  s_mov_b64 exec, 0xffff
  ds_write_b32 v12, v152
  s_mov_b64 exec, -1
  v_lshlrev_b32 v12, 2, v8
  v_add_u32 v12, 132336, v12
  s_mov_b64 exec, 0xffff
  ds_write_b32 v12, v156
  s_mov_b64 exec, -1
  v_lshrrev_b32 v9, 4, v0
  v_lshlrev_b32 v12, 4, v9
  v_add_u32 v12, 131072, v12
  s_mov_b32 s50, 0x01000100
  s_mov_b32 s51, 0x01000100
  s_mov_b64 exec, s[50:51]
  ds_write_b128 v12, v[88:91] offset:0
  ds_write_b128 v12, v[104:107] offset:64
  ds_write_b128 v12, v[120:123] offset:128
  ds_write_b128 v12, v[136:139] offset:192
  s_mov_b64 exec, -1
  s_branch L1_fins
L1_loop2:
  s_add_u32 s30, s30, 32768
  s_cmp_eq_u32 s30, 131072
  s_cselect_b32 s40, -98304, s52
  s_cselect_b32 s30, 0, s30
  s_waitcnt lgkmcnt(0)
  v_mfma_f32_16x16x32_bf16 v[80:83], v[16:19], v[32:35], v[80:83]
  ds_read_b128 v[48:51], v3 offset:0
  v_mfma_f32_16x16x32_bf16 v[84:87], v[16:19], v[36:39], v[84:87]
  ds_read_b128 v[52:55], v3 offset:2048
  v_mfma_f32_16x16x32_bf16 v[88:91], v[16:19], v[40:43], v[88:91]
  ds_read_b128 v[56:59], v3 offset:4096
  v_mfma_f32_16x16x32_bf16 v[92:95], v[44:47], v[16:19], v[92:95]
  ds_read_b128 v[60:63], v3 offset:6144
  v_mfma_f32_16x16x32_bf16 v[96:99], v[20:23], v[32:35], v[96:99]
  ds_read_b64_tr_b16 v[64:65], v4 offset:8192
  v_mfma_f32_16x16x32_bf16 v[100:103], v[20:23], v[36:39], v[100:103]
  ds_read_b64_tr_b16 v[66:67], v4 offset:9216
  v_mfma_f32_16x16x32_bf16 v[104:107], v[20:23], v[40:43], v[104:107]
  ds_read_b64_tr_b16 v[68:69], v5 offset:8192
  v_mfma_f32_16x16x32_bf16 v[108:111], v[44:47], v[20:23], v[108:111]
  ds_read_b64_tr_b16 v[70:71], v5 offset:9216
  v_mfma_f32_16x16x32_bf16 v[144:147], v[16:19], v[16:19], v[144:147]
  ds_read_b64_tr_b16 v[72:73], v6 offset:8192
  v_mfma_f32_16x16x32_bf16 v[148:151], v[20:23], v[20:23], v[148:151]
  ds_read_b64_tr_b16 v[74:75], v6 offset:9216
  v_mfma_f32_16x16x32_bf16 v[112:115], v[24:27], v[32:35], v[112:115]
  ds_read_b64_tr_b16 v[76:77], v7 offset:8192
  v_mfma_f32_16x16x32_bf16 v[116:119], v[24:27], v[36:39], v[116:119]
  ds_read_b64_tr_b16 v[78:79], v7 offset:9216
  v_mfma_f32_16x16x32_bf16 v[120:123], v[24:27], v[40:43], v[120:123]
  v_add_u32 v2, s40, v2
  v_mfma_f32_16x16x32_bf16 v[124:127], v[44:47], v[24:27], v[124:127]
  v_add_u32 v3, s40, v3
  v_mfma_f32_16x16x32_bf16 v[128:131], v[28:31], v[32:35], v[128:131]
  v_add_u32 v4, s40, v4
  v_mfma_f32_16x16x32_bf16 v[132:135], v[28:31], v[36:39], v[132:135]
  v_add_u32 v5, s40, v5
  v_mfma_f32_16x16x32_bf16 v[136:139], v[28:31], v[40:43], v[136:139]
  v_add_u32 v6, s40, v6
  v_mfma_f32_16x16x32_bf16 v[140:143], v[44:47], v[28:31], v[140:143]
  v_add_u32 v7, s40, v7
  v_mfma_f32_16x16x32_bf16 v[152:155], v[160:163], v[40:43], v[152:155]
  v_mfma_f32_16x16x32_bf16 v[156:159], v[160:163], v[44:47], v[156:159]
  s_cmp_eq_u32 s29, 9
  s_cbranch_scc1 L1_last2
  s_add_u32 s29, s29, 1
  s_waitcnt lgkmcnt(0)
  s_barrier
  v_mfma_f32_16x16x32_bf16 v[80:83], v[48:51], v[64:67], v[80:83]
  ds_read_b128 v[16:19], v2 offset:0
  v_mfma_f32_16x16x32_bf16 v[84:87], v[48:51], v[68:71], v[84:87]
  ds_read_b128 v[20:23], v2 offset:2048
  v_mfma_f32_16x16x32_bf16 v[88:91], v[48:51], v[72:75], v[88:91]
  ds_read_b128 v[24:27], v2 offset:4096
  v_mfma_f32_16x16x32_bf16 v[92:95], v[76:79], v[48:51], v[92:95]
  ds_read_b128 v[28:31], v2 offset:6144
  v_mfma_f32_16x16x32_bf16 v[96:99], v[52:55], v[64:67], v[96:99]
  ds_read_b64_tr_b16 v[32:33], v4 offset:0
  v_mfma_f32_16x16x32_bf16 v[100:103], v[52:55], v[68:71], v[100:103]
  ds_read_b64_tr_b16 v[34:35], v4 offset:1024
  v_mfma_f32_16x16x32_bf16 v[104:107], v[52:55], v[72:75], v[104:107]
  ds_read_b64_tr_b16 v[36:37], v5 offset:0
  v_mfma_f32_16x16x32_bf16 v[108:111], v[76:79], v[52:55], v[108:111]
  ds_read_b64_tr_b16 v[38:39], v5 offset:1024
  v_mfma_f32_16x16x32_bf16 v[144:147], v[48:51], v[48:51], v[144:147]
  ds_read_b64_tr_b16 v[40:41], v6 offset:0
  v_mfma_f32_16x16x32_bf16 v[148:151], v[52:55], v[52:55], v[148:151]
  ds_read_b64_tr_b16 v[42:43], v6 offset:1024
  v_mfma_f32_16x16x32_bf16 v[112:115], v[56:59], v[64:67], v[112:115]
  ds_read_b64_tr_b16 v[44:45], v7 offset:0
  v_mfma_f32_16x16x32_bf16 v[116:119], v[56:59], v[68:71], v[116:119]
  ds_read_b64_tr_b16 v[46:47], v7 offset:1024
  v_mfma_f32_16x16x32_bf16 v[120:123], v[56:59], v[72:75], v[120:123]
  v_mfma_f32_16x16x32_bf16 v[124:127], v[76:79], v[56:59], v[124:127]
  v_mfma_f32_16x16x32_bf16 v[128:131], v[60:63], v[64:67], v[128:131]
  v_mfma_f32_16x16x32_bf16 v[132:135], v[60:63], v[68:71], v[132:135]
  v_mfma_f32_16x16x32_bf16 v[136:139], v[60:63], v[72:75], v[136:139]
  v_mfma_f32_16x16x32_bf16 v[140:143], v[76:79], v[60:63], v[140:143]
  v_mfma_f32_16x16x32_bf16 v[152:155], v[160:163], v[72:75], v[152:155]
  v_mfma_f32_16x16x32_bf16 v[156:159], v[160:163], v[76:79], v[156:159]
  s_branch L1_loop2
L1_last2:
  s_waitcnt lgkmcnt(0)
  v_mfma_f32_16x16x32_bf16 v[80:83], v[48:51], v[64:67], v[80:83]
  v_mfma_f32_16x16x32_bf16 v[84:87], v[48:51], v[68:71], v[84:87]
  v_mfma_f32_16x16x32_bf16 v[88:91], v[48:51], v[72:75], v[88:91]
  v_mfma_f32_16x16x32_bf16 v[92:95], v[76:79], v[48:51], v[92:95]
  v_mfma_f32_16x16x32_bf16 v[96:99], v[52:55], v[64:67], v[96:99]
  v_mfma_f32_16x16x32_bf16 v[100:103], v[52:55], v[68:71], v[100:103]
  v_mfma_f32_16x16x32_bf16 v[104:107], v[52:55], v[72:75], v[104:107]
  v_mfma_f32_16x16x32_bf16 v[108:111], v[76:79], v[52:55], v[108:111]
  v_mfma_f32_16x16x32_bf16 v[144:147], v[48:51], v[48:51], v[144:147]
  v_mfma_f32_16x16x32_bf16 v[148:151], v[52:55], v[52:55], v[148:151]
  v_mfma_f32_16x16x32_bf16 v[112:115], v[56:59], v[64:67], v[112:115]
  v_mfma_f32_16x16x32_bf16 v[116:119], v[56:59], v[68:71], v[116:119]
  v_mfma_f32_16x16x32_bf16 v[120:123], v[56:59], v[72:75], v[120:123]
  v_mfma_f32_16x16x32_bf16 v[124:127], v[76:79], v[56:59], v[124:127]
  v_mfma_f32_16x16x32_bf16 v[128:131], v[60:63], v[64:67], v[128:131]
  v_mfma_f32_16x16x32_bf16 v[132:135], v[60:63], v[68:71], v[132:135]
  v_mfma_f32_16x16x32_bf16 v[136:139], v[60:63], v[72:75], v[136:139]
  v_mfma_f32_16x16x32_bf16 v[140:143], v[76:79], v[60:63], v[140:143]
  v_mfma_f32_16x16x32_bf16 v[152:155], v[160:163], v[72:75], v[152:155]
  v_mfma_f32_16x16x32_bf16 v[156:159], v[160:163], v[76:79], v[156:159]
  v_lshrrev_b32 v9, 4, v0
  v_lshrrev_b32 v10, 2, v8
  v_cmp_eq_u32 s[50:51], v9, v10
  v_and_b32 v10, 3, v8
  s_nop 7
  v_mov_b32 v11, v144
  v_cmp_eq_u32 vcc, 1, v10
  s_nop 1
  v_cndmask_b32 v11, v11, v145, vcc
  v_cmp_eq_u32 vcc, 2, v10
  s_nop 1
  v_cndmask_b32 v11, v11, v146, vcc
  v_cmp_eq_u32 vcc, 3, v10
  s_nop 1
  v_cndmask_b32 v11, v11, v147, vcc
  v_lshlrev_b32 v12, 2, v8
  v_add_u32 v12, 131840, v12
  s_mov_b64 exec, s[50:51]
  ds_write_b32 v12, v11
  s_mov_b64 exec, -1
  v_mov_b32 v11, v148
  v_cmp_eq_u32 vcc, 1, v10
  s_nop 1
  v_cndmask_b32 v11, v11, v149, vcc
  v_cmp_eq_u32 vcc, 2, v10
  s_nop 1
  v_cndmask_b32 v11, v11, v150, vcc
  v_cmp_eq_u32 vcc, 3, v10
  s_nop 1
  v_cndmask_b32 v11, v11, v151, vcc
  v_lshlrev_b32 v12, 2, v8
  v_add_u32 v12, 131904, v12
  s_mov_b64 exec, s[50:51]
  ds_write_b32 v12, v11
  s_mov_b64 exec, -1
  v_lshlrev_b32 v12, 2, v8
  v_add_u32 v11, 64, v12
  v_add_u32 v9, 208, v12
  v_cmp_gt_u32 vcc, 4, v8
  s_nop 1
  v_cndmask_b32 v11, v9, v11, vcc
  v_add_u32 v9, 416, v12
  v_cmp_gt_u32 vcc, 8, v8
  s_nop 1
  v_cndmask_b32 v12, v9, v11, vcc
  v_add_u32 v12, 132096, v12
  s_mov_b64 exec, 0xffff
  ds_write_b32 v12, v152
  s_mov_b64 exec, -1
  v_lshlrev_b32 v12, 2, v8
  v_add_u32 v12, 132416, v12
  s_mov_b64 exec, 0xffff
  ds_write_b32 v12, v156
  s_mov_b64 exec, -1
  s_branch L1_fins
L1_loop3:
  s_add_u32 s30, s30, 32768
  s_cmp_eq_u32 s30, 131072
  s_cselect_b32 s40, -98304, s52
  s_cselect_b32 s30, 0, s30
  s_waitcnt lgkmcnt(0)
  v_cndmask_b32 v40, v40, v160, s[48:49]
  ds_read_b128 v[48:51], v3 offset:0
  v_cndmask_b32 v41, v41, v160, s[48:49]
  ds_read_b128 v[52:55], v3 offset:2048
  v_cndmask_b32 v42, v42, v160, s[48:49]
  ds_read_b128 v[56:59], v3 offset:4096
  v_cndmask_b32 v43, v43, v160, s[48:49]
  ds_read_b128 v[60:63], v3 offset:6144
  v_mfma_f32_16x16x32_bf16 v[80:83], v[16:19], v[32:35], v[80:83]
  ds_read_b64_tr_b16 v[64:65], v4 offset:8192
  v_mfma_f32_16x16x32_bf16 v[84:87], v[16:19], v[36:39], v[84:87]
  ds_read_b64_tr_b16 v[66:67], v4 offset:9216
  v_mfma_f32_16x16x32_bf16 v[88:91], v[16:19], v[40:43], v[88:91]
  ds_read_b64_tr_b16 v[68:69], v5 offset:8192
  v_mfma_f32_16x16x32_bf16 v[92:95], v[44:47], v[16:19], v[92:95]
  ds_read_b64_tr_b16 v[70:71], v5 offset:9216
  v_mfma_f32_16x16x32_bf16 v[96:99], v[20:23], v[32:35], v[96:99]
  ds_read_b64_tr_b16 v[72:73], v6 offset:8192
  v_mfma_f32_16x16x32_bf16 v[100:103], v[20:23], v[36:39], v[100:103]
  ds_read_b64_tr_b16 v[74:75], v6 offset:9216
  v_mfma_f32_16x16x32_bf16 v[104:107], v[20:23], v[40:43], v[104:107]
  ds_read_b64_tr_b16 v[76:77], v7 offset:8192
  v_mfma_f32_16x16x32_bf16 v[108:111], v[44:47], v[20:23], v[108:111]
  ds_read_b64_tr_b16 v[78:79], v7 offset:9216
  v_mfma_f32_16x16x32_bf16 v[144:147], v[24:27], v[24:27], v[144:147]
  v_add_u32 v2, s40, v2
  v_mfma_f32_16x16x32_bf16 v[148:151], v[28:31], v[28:31], v[148:151]
  v_add_u32 v3, s40, v3
  v_mfma_f32_16x16x32_bf16 v[112:115], v[24:27], v[32:35], v[112:115]
  v_add_u32 v4, s40, v4
  v_mfma_f32_16x16x32_bf16 v[116:119], v[24:27], v[36:39], v[116:119]
  v_add_u32 v5, s40, v5
  v_mfma_f32_16x16x32_bf16 v[120:123], v[24:27], v[40:43], v[120:123]
  v_add_u32 v6, s40, v6
  v_mfma_f32_16x16x32_bf16 v[124:127], v[44:47], v[24:27], v[124:127]
  v_add_u32 v7, s40, v7
  v_mfma_f32_16x16x32_bf16 v[128:131], v[28:31], v[32:35], v[128:131]
  v_mfma_f32_16x16x32_bf16 v[132:135], v[28:31], v[36:39], v[132:135]
  v_mfma_f32_16x16x32_bf16 v[136:139], v[28:31], v[40:43], v[136:139]
  v_mfma_f32_16x16x32_bf16 v[140:143], v[44:47], v[28:31], v[140:143]
  v_mfma_f32_16x16x32_bf16 v[152:155], v[160:163], v[40:43], v[152:155]
  v_mfma_f32_16x16x32_bf16 v[156:159], v[160:163], v[44:47], v[156:159]
  s_cmp_eq_u32 s29, 9
  s_cbranch_scc1 L1_last3
  s_add_u32 s29, s29, 1
  s_waitcnt lgkmcnt(0)
  s_barrier
  v_cndmask_b32 v72, v72, v160, s[48:49]
  ds_read_b128 v[16:19], v2 offset:0
  v_cndmask_b32 v73, v73, v160, s[48:49]
  ds_read_b128 v[20:23], v2 offset:2048
  v_cndmask_b32 v74, v74, v160, s[48:49]
  ds_read_b128 v[24:27], v2 offset:4096
  v_cndmask_b32 v75, v75, v160, s[48:49]
  ds_read_b128 v[28:31], v2 offset:6144
  v_mfma_f32_16x16x32_bf16 v[80:83], v[48:51], v[64:67], v[80:83]
  ds_read_b64_tr_b16 v[32:33], v4 offset:0
  v_mfma_f32_16x16x32_bf16 v[84:87], v[48:51], v[68:71], v[84:87]
  ds_read_b64_tr_b16 v[34:35], v4 offset:1024
  v_mfma_f32_16x16x32_bf16 v[88:91], v[48:51], v[72:75], v[88:91]
  ds_read_b64_tr_b16 v[36:37], v5 offset:0
  v_mfma_f32_16x16x32_bf16 v[92:95], v[76:79], v[48:51], v[92:95]
  ds_read_b64_tr_b16 v[38:39], v5 offset:1024
  v_mfma_f32_16x16x32_bf16 v[96:99], v[52:55], v[64:67], v[96:99]
  ds_read_b64_tr_b16 v[40:41], v6 offset:0
  v_mfma_f32_16x16x32_bf16 v[100:103], v[52:55], v[68:71], v[100:103]
  ds_read_b64_tr_b16 v[42:43], v6 offset:1024
  v_mfma_f32_16x16x32_bf16 v[104:107], v[52:55], v[72:75], v[104:107]
  ds_read_b64_tr_b16 v[44:45], v7 offset:0
  v_mfma_f32_16x16x32_bf16 v[108:111], v[76:79], v[52:55], v[108:111]
  ds_read_b64_tr_b16 v[46:47], v7 offset:1024
  v_mfma_f32_16x16x32_bf16 v[144:147], v[56:59], v[56:59], v[144:147]
  v_mfma_f32_16x16x32_bf16 v[148:151], v[60:63], v[60:63], v[148:151]
  v_mfma_f32_16x16x32_bf16 v[112:115], v[56:59], v[64:67], v[112:115]
  v_mfma_f32_16x16x32_bf16 v[116:119], v[56:59], v[68:71], v[116:119]
  v_mfma_f32_16x16x32_bf16 v[120:123], v[56:59], v[72:75], v[120:123]
  v_mfma_f32_16x16x32_bf16 v[124:127], v[76:79], v[56:59], v[124:127]
  v_mfma_f32_16x16x32_bf16 v[128:131], v[60:63], v[64:67], v[128:131]
  v_mfma_f32_16x16x32_bf16 v[132:135], v[60:63], v[68:71], v[132:135]
  v_mfma_f32_16x16x32_bf16 v[136:139], v[60:63], v[72:75], v[136:139]
  v_mfma_f32_16x16x32_bf16 v[140:143], v[76:79], v[60:63], v[140:143]
  v_mfma_f32_16x16x32_bf16 v[152:155], v[160:163], v[72:75], v[152:155]
  v_mfma_f32_16x16x32_bf16 v[156:159], v[160:163], v[76:79], v[156:159]
  s_branch L1_loop3
L1_last3:
  s_waitcnt lgkmcnt(0)
  v_cndmask_b32 v72, v72, v160, s[48:49]
  v_cndmask_b32 v73, v73, v160, s[48:49]
  v_cndmask_b32 v74, v74, v160, s[48:49]
  v_cndmask_b32 v75, v75, v160, s[48:49]
  v_mfma_f32_16x16x32_bf16 v[80:83], v[48:51], v[64:67], v[80:83]
  v_mfma_f32_16x16x32_bf16 v[84:87], v[48:51], v[68:71], v[84:87]
  v_mfma_f32_16x16x32_bf16 v[88:91], v[48:51], v[72:75], v[88:91]
  v_mfma_f32_16x16x32_bf16 v[92:95], v[76:79], v[48:51], v[92:95]
  v_mfma_f32_16x16x32_bf16 v[96:99], v[52:55], v[64:67], v[96:99]
  v_mfma_f32_16x16x32_bf16 v[100:103], v[52:55], v[68:71], v[100:103]
  v_mfma_f32_16x16x32_bf16 v[104:107], v[52:55], v[72:75], v[104:107]
  v_mfma_f32_16x16x32_bf16 v[108:111], v[76:79], v[52:55], v[108:111]
  v_mfma_f32_16x16x32_bf16 v[144:147], v[56:59], v[56:59], v[144:147]
  v_mfma_f32_16x16x32_bf16 v[148:151], v[60:63], v[60:63], v[148:151]
  v_mfma_f32_16x16x32_bf16 v[112:115], v[56:59], v[64:67], v[112:115]
  v_mfma_f32_16x16x32_bf16 v[116:119], v[56:59], v[68:71], v[116:119]
  v_mfma_f32_16x16x32_bf16 v[120:123], v[56:59], v[72:75], v[120:123]
  v_mfma_f32_16x16x32_bf16 v[124:127], v[76:79], v[56:59], v[124:127]
  v_mfma_f32_16x16x32_bf16 v[128:131], v[60:63], v[64:67], v[128:131]
  v_mfma_f32_16x16x32_bf16 v[132:135], v[60:63], v[68:71], v[132:135]
  v_mfma_f32_16x16x32_bf16 v[136:139], v[60:63], v[72:75], v[136:139]
  v_mfma_f32_16x16x32_bf16 v[140:143], v[76:79], v[60:63], v[140:143]
  v_mfma_f32_16x16x32_bf16 v[152:155], v[160:163], v[72:75], v[152:155]
  v_mfma_f32_16x16x32_bf16 v[156:159], v[160:163], v[76:79], v[156:159]
  v_lshrrev_b32 v9, 4, v0
  v_lshrrev_b32 v10, 2, v8
  v_cmp_eq_u32 s[50:51], v9, v10
  v_and_b32 v10, 3, v8
  s_nop 7
  v_mov_b32 v11, v144
  v_cmp_eq_u32 vcc, 1, v10
  s_nop 1
  v_cndmask_b32 v11, v11, v145, vcc
  v_cmp_eq_u32 vcc, 2, v10
  s_nop 1
  v_cndmask_b32 v11, v11, v146, vcc
  v_cmp_eq_u32 vcc, 3, v10
  s_nop 1
  v_cndmask_b32 v11, v11, v147, vcc
  v_lshlrev_b32 v12, 2, v8
  v_add_u32 v12, 131968, v12
  s_mov_b64 exec, s[50:51]
  ds_write_b32 v12, v11
  s_mov_b64 exec, -1
  v_mov_b32 v11, v148
  v_cmp_eq_u32 vcc, 1, v10
  s_nop 1
  v_cndmask_b32 v11, v11, v149, vcc
  v_cmp_eq_u32 vcc, 2, v10
  s_nop 1
  v_cndmask_b32 v11, v11, v150, vcc
  v_cmp_eq_u32 vcc, 3, v10
  s_nop 1
  v_cndmask_b32 v11, v11, v151, vcc
  v_lshlrev_b32 v12, 2, v8
  v_add_u32 v12, 132032, v12
  s_mov_b64 exec, s[50:51]
  ds_write_b32 v12, v11
  s_mov_b64 exec, -1
  v_lshlrev_b32 v12, 2, v8
  v_add_u32 v11, 144, v12
  v_add_u32 v9, 288, v12
  v_cmp_gt_u32 vcc, 4, v8
  s_nop 1
  v_cndmask_b32 v11, v9, v11, vcc
  v_add_u32 v9, 416, v12
  v_cmp_gt_u32 vcc, 8, v8
  s_nop 1
  v_cndmask_b32 v12, v9, v11, vcc
  v_add_u32 v12, 132096, v12
  s_mov_b64 exec, 0xff
  ds_write_b32 v12, v152
  s_mov_b64 exec, -1
  v_lshlrev_b32 v12, 2, v8
  v_add_u32 v12, 132480, v12
  s_mov_b64 exec, 0xffff
  ds_write_b32 v12, v156
  s_mov_b64 exec, -1
  v_lshrrev_b32 v9, 4, v0
  v_lshlrev_b32 v12, 4, v9
  v_add_u32 v12, 131328, v12
  s_mov_b32 s50, 0x01000100
  s_mov_b32 s51, 0x01000100
  s_mov_b64 exec, s[50:51]
  ds_write_b128 v12, v[88:91] offset:0
  ds_write_b128 v12, v[104:107] offset:64
  ds_write_b128 v12, v[120:123] offset:128
  ds_write_b128 v12, v[136:139] offset:192
  s_mov_b64 exec, -1
  s_branch L1_fins
L1_fins:
  s_waitcnt lgkmcnt(0)
  s_barrier
  s_cmp_ge_u32 s26, 2
  s_cbranch_scc1 L1_fb
  v_lshl_or_b32 v11, s26, 6, v0
  v_lshlrev_b32 v12, 2, v11
  v_add_u32 v12, 131072, v12
  ds_read_b32 v16, v12
  ds_read_b32 v17, v12 offset:512
  s_waitcnt lgkmcnt(0)
  s_mov_b32 s40, 0x3acccccd
  v_mul_f32 v16, s40, v16
  v_mul_f32 v17, s40, v17
  v_fma_f32 v17, -v16, v16, v17
  v_max_f32 v17, 0, v17
  v_add_f32 v17, 0x3727c5ac, v17
  v_rsq_f32 v17, v17
  v_lshlrev_b32 v12, 2, v11
  v_add_u32 v12, 133120, v12
  ds_write_b32 v12, v16
  ds_write_b32 v12, v17 offset:512
  s_waitcnt lgkmcnt(0)
L1_fb:
  s_barrier
  s_mov_b32 s45, 0x3fb8aa3b
  s_waitcnt vmcnt(0)
  v_and_b32 v8, 15, v0
  v_lshrrev_b32 v9, 4, v0
  s_lshl_b32 s40, s27, 8
  s_add_u32 s40, s40, 133120
  v_lshl_add_u32 v10, v8, 2, s40
  v_lshl_add_u32 v11, v9, 4, s40
  ds_read_b128 v[20:23], v11 offset:0
  ds_read_b128 v[36:39], v11 offset:512
  ds_read_b32 v52, v10 offset:0
  ds_read_b32 v53, v10 offset:512
  ds_read_b128 v[24:27], v11 offset:64
  ds_read_b128 v[40:43], v11 offset:576
  ds_read_b32 v54, v10 offset:64
  ds_read_b32 v55, v10 offset:576
  ds_read_b128 v[28:31], v11 offset:128
  ds_read_b128 v[44:47], v11 offset:640
  ds_read_b32 v56, v10 offset:128
  ds_read_b32 v57, v10 offset:640
  ds_read_b128 v[32:35], v11 offset:192
  ds_read_b128 v[48:51], v11 offset:704
  ds_read_b32 v58, v10 offset:192
  ds_read_b32 v59, v10 offset:704
  s_mul_i32 s41, s28, 80
  s_add_u32 s41, s41, 132096
  v_lshl_add_u32 v10, v8, 2, s41
  ds_read_b32 v2, v10
  ds_read_b32 v4, v10 offset:160
  v_add_u32 v11, 64, v10
  v_add_u32 v12, 208, v10
  v_cmp_gt_u32 vcc, 4, v8
  s_nop 1
  v_cndmask_b32 v11, v12, v11, vcc
  v_lshlrev_b32 v12, 2, v8
  v_add_u32 v12, 132512, v12
  v_cmp_gt_u32 vcc, 8, v8
  s_nop 1
  v_cndmask_b32 v11, v12, v11, vcc
  ds_read_b32 v6, v11
  s_lshl_b32 s41, s28, 6
  s_add_u32 s41, s41, 132416
  v_lshl_add_u32 v11, v9, 4, s41
  ds_read_b128 v[16:19], v11
  s_mov_b32 s46, 0x358637bd
  v_and_b32 v10, 12, v8
  v_cmp_eq_u32 s[48:49], 4, v10
  s_waitcnt lgkmcnt(0)
  s_mov_b32 s54, s45
  s_mov_b32 s55, s45
  s_mov_b32 s56, s46
  s_mov_b32 s57, s46
  v_pk_fma_f32 v[80:81], v[20:21], v[2:3], v[80:81] op_sel_hi:[1,0,1] neg_lo:[1,0,0] neg_hi:[1,0,0]
  v_pk_fma_f32 v[82:83], v[22:23], v[2:3], v[82:83] op_sel_hi:[1,0,1] neg_lo:[1,0,0] neg_hi:[1,0,0]
  v_pk_mul_f32 v[80:81], v[80:81], v[36:37]
  v_pk_mul_f32 v[82:83], v[82:83], v[38:39]
  v_pk_fma_f32 v[84:85], v[20:21], v[4:5], v[84:85] op_sel_hi:[1,0,1] neg_lo:[1,0,0] neg_hi:[1,0,0]
  v_pk_fma_f32 v[86:87], v[22:23], v[4:5], v[86:87] op_sel_hi:[1,0,1] neg_lo:[1,0,0] neg_hi:[1,0,0]
  v_pk_mul_f32 v[84:85], v[84:85], v[36:37]
  v_pk_mul_f32 v[86:87], v[86:87], v[38:39]
  v_pk_fma_f32 v[88:89], v[20:21], v[6:7], v[88:89] op_sel_hi:[1,0,1] neg_lo:[1,0,0] neg_hi:[1,0,0]
  v_pk_fma_f32 v[90:91], v[22:23], v[6:7], v[90:91] op_sel_hi:[1,0,1] neg_lo:[1,0,0] neg_hi:[1,0,0]
  v_pk_mul_f32 v[88:89], v[88:89], v[36:37]
  v_pk_mul_f32 v[90:91], v[90:91], v[38:39]
  v_pk_fma_f32 v[92:93], v[16:17], v[52:53], v[92:93] op_sel_hi:[1,0,1] neg_lo:[0,1,0] neg_hi:[0,1,0]
  v_pk_fma_f32 v[94:95], v[18:19], v[52:53], v[94:95] op_sel_hi:[1,0,1] neg_lo:[0,1,0] neg_hi:[0,1,0]
  v_pk_mul_f32 v[92:93], v[92:93], v[52:53] op_sel:[0,1] op_sel_hi:[1,1]
  v_pk_mul_f32 v[94:95], v[94:95], v[52:53] op_sel:[0,1] op_sel_hi:[1,1]
  v_min_f32 v160, 0, v80
  v_min_f32 v161, 0, v81
  v_min_f32 v162, 0, v82
  v_min_f32 v163, 0, v83
  v_pk_mul_f32 v[160:161], v[160:161], s[54:55]
  v_pk_mul_f32 v[162:163], v[162:163], s[54:55]
  v_exp_f32 v160, v160
  v_exp_f32 v161, v161
  v_exp_f32 v162, v162
  v_exp_f32 v163, v163
  v_max_f32 v80, 0, v80
  v_max_f32 v81, 0, v81
  v_max_f32 v82, 0, v82
  v_max_f32 v83, 0, v83
  v_pk_add_f32 v[160:161], v[160:161], s[56:57]
  v_pk_add_f32 v[162:163], v[162:163], s[56:57]
  v_pk_add_f32 v[80:81], v[80:81], v[160:161]
  v_pk_add_f32 v[82:83], v[82:83], v[162:163]
  v_min_f32 v160, 0, v92
  v_min_f32 v161, 0, v93
  v_min_f32 v162, 0, v94
  v_min_f32 v163, 0, v95
  v_pk_mul_f32 v[160:161], v[160:161], s[54:55]
  v_pk_mul_f32 v[162:163], v[162:163], s[54:55]
  v_exp_f32 v160, v160
  v_exp_f32 v161, v161
  v_exp_f32 v162, v162
  v_exp_f32 v163, v163
  v_max_f32 v92, 0, v92
  v_max_f32 v93, 0, v93
  v_max_f32 v94, 0, v94
  v_max_f32 v95, 0, v95
  v_pk_add_f32 v[160:161], v[160:161], s[56:57]
  v_pk_add_f32 v[162:163], v[162:163], s[56:57]
  v_pk_add_f32 v[92:93], v[92:93], v[160:161]
  v_pk_add_f32 v[94:95], v[94:95], v[162:163]
  v_mov_b32 v164, v88
  v_mov_b32 v165, v89
  v_mov_b32 v166, v90
  v_mov_b32 v167, v91
  v_min_f32 v160, 0, v88
  v_min_f32 v161, 0, v89
  v_min_f32 v162, 0, v90
  v_min_f32 v163, 0, v91
  v_pk_mul_f32 v[160:161], v[160:161], s[54:55]
  v_pk_mul_f32 v[162:163], v[162:163], s[54:55]
  v_exp_f32 v160, v160
  v_exp_f32 v161, v161
  v_exp_f32 v162, v162
  v_exp_f32 v163, v163
  v_max_f32 v88, 0, v88
  v_max_f32 v89, 0, v89
  v_max_f32 v90, 0, v90
  v_max_f32 v91, 0, v91
  v_pk_add_f32 v[160:161], v[160:161], s[56:57]
  v_pk_add_f32 v[162:163], v[162:163], s[56:57]
  v_pk_add_f32 v[88:89], v[88:89], v[160:161]
  v_pk_add_f32 v[90:91], v[90:91], v[162:163]
  v_cndmask_b32 v88, v88, v164, s[48:49]
  v_cndmask_b32 v89, v89, v165, s[48:49]
  v_cndmask_b32 v90, v90, v166, s[48:49]
  v_cndmask_b32 v91, v91, v167, s[48:49]
  v_cvt_pk_bf16_f32 v64, v80, v81
  v_cvt_pk_bf16_f32 v65, v82, v83
  v_cvt_pk_bf16_f32 v72, v84, v85
  v_cvt_pk_bf16_f32 v73, v86, v87
  v_cvt_pk_bf16_f32 v144, v88, v89
  v_cvt_pk_bf16_f32 v145, v90, v91
  v_cvt_pk_bf16_f32 v152, v92, v93
  v_cvt_pk_bf16_f32 v153, v94, v95
  v_pk_fma_f32 v[96:97], v[24:25], v[2:3], v[96:97] op_sel_hi:[1,0,1] neg_lo:[1,0,0] neg_hi:[1,0,0]
  v_pk_fma_f32 v[98:99], v[26:27], v[2:3], v[98:99] op_sel_hi:[1,0,1] neg_lo:[1,0,0] neg_hi:[1,0,0]
  v_pk_mul_f32 v[96:97], v[96:97], v[40:41]
  v_pk_mul_f32 v[98:99], v[98:99], v[42:43]
  v_pk_fma_f32 v[100:101], v[24:25], v[4:5], v[100:101] op_sel_hi:[1,0,1] neg_lo:[1,0,0] neg_hi:[1,0,0]
  v_pk_fma_f32 v[102:103], v[26:27], v[4:5], v[102:103] op_sel_hi:[1,0,1] neg_lo:[1,0,0] neg_hi:[1,0,0]
  v_pk_mul_f32 v[100:101], v[100:101], v[40:41]
  v_pk_mul_f32 v[102:103], v[102:103], v[42:43]
  v_pk_fma_f32 v[104:105], v[24:25], v[6:7], v[104:105] op_sel_hi:[1,0,1] neg_lo:[1,0,0] neg_hi:[1,0,0]
  v_pk_fma_f32 v[106:107], v[26:27], v[6:7], v[106:107] op_sel_hi:[1,0,1] neg_lo:[1,0,0] neg_hi:[1,0,0]
  v_pk_mul_f32 v[104:105], v[104:105], v[40:41]
  v_pk_mul_f32 v[106:107], v[106:107], v[42:43]
  v_pk_fma_f32 v[108:109], v[16:17], v[54:55], v[108:109] op_sel_hi:[1,0,1] neg_lo:[0,1,0] neg_hi:[0,1,0]
  v_pk_fma_f32 v[110:111], v[18:19], v[54:55], v[110:111] op_sel_hi:[1,0,1] neg_lo:[0,1,0] neg_hi:[0,1,0]
  v_pk_mul_f32 v[108:109], v[108:109], v[54:55] op_sel:[0,1] op_sel_hi:[1,1]
  v_pk_mul_f32 v[110:111], v[110:111], v[54:55] op_sel:[0,1] op_sel_hi:[1,1]
  v_min_f32 v160, 0, v96
  v_min_f32 v161, 0, v97
  v_min_f32 v162, 0, v98
  v_min_f32 v163, 0, v99
  v_pk_mul_f32 v[160:161], v[160:161], s[54:55]
  v_pk_mul_f32 v[162:163], v[162:163], s[54:55]
  v_exp_f32 v160, v160
  v_exp_f32 v161, v161
  v_exp_f32 v162, v162
  v_exp_f32 v163, v163
  v_max_f32 v96, 0, v96
  v_max_f32 v97, 0, v97
  v_max_f32 v98, 0, v98
  v_max_f32 v99, 0, v99
  v_pk_add_f32 v[160:161], v[160:161], s[56:57]
  v_pk_add_f32 v[162:163], v[162:163], s[56:57]
  v_pk_add_f32 v[96:97], v[96:97], v[160:161]
  v_pk_add_f32 v[98:99], v[98:99], v[162:163]
  v_min_f32 v160, 0, v108
  v_min_f32 v161, 0, v109
  v_min_f32 v162, 0, v110
  v_min_f32 v163, 0, v111
  v_pk_mul_f32 v[160:161], v[160:161], s[54:55]
  v_pk_mul_f32 v[162:163], v[162:163], s[54:55]
  v_exp_f32 v160, v160
  v_exp_f32 v161, v161
  v_exp_f32 v162, v162
  v_exp_f32 v163, v163
  v_max_f32 v108, 0, v108
  v_max_f32 v109, 0, v109
  v_max_f32 v110, 0, v110
  v_max_f32 v111, 0, v111
  v_pk_add_f32 v[160:161], v[160:161], s[56:57]
  v_pk_add_f32 v[162:163], v[162:163], s[56:57]
  v_pk_add_f32 v[108:109], v[108:109], v[160:161]
  v_pk_add_f32 v[110:111], v[110:111], v[162:163]
  v_mov_b32 v164, v104
  v_mov_b32 v165, v105
  v_mov_b32 v166, v106
  v_mov_b32 v167, v107
  v_min_f32 v160, 0, v104
  v_min_f32 v161, 0, v105
  v_min_f32 v162, 0, v106
  v_min_f32 v163, 0, v107
  v_pk_mul_f32 v[160:161], v[160:161], s[54:55]
  v_pk_mul_f32 v[162:163], v[162:163], s[54:55]
  v_exp_f32 v160, v160
  v_exp_f32 v161, v161
  v_exp_f32 v162, v162
  v_exp_f32 v163, v163
  v_max_f32 v104, 0, v104
  v_max_f32 v105, 0, v105
  v_max_f32 v106, 0, v106
  v_max_f32 v107, 0, v107
  v_pk_add_f32 v[160:161], v[160:161], s[56:57]
  v_pk_add_f32 v[162:163], v[162:163], s[56:57]
  v_pk_add_f32 v[104:105], v[104:105], v[160:161]
  v_pk_add_f32 v[106:107], v[106:107], v[162:163]
  v_cndmask_b32 v104, v104, v164, s[48:49]
  v_cndmask_b32 v105, v105, v165, s[48:49]
  v_cndmask_b32 v106, v106, v166, s[48:49]
  v_cndmask_b32 v107, v107, v167, s[48:49]
  v_cvt_pk_bf16_f32 v66, v96, v97
  v_cvt_pk_bf16_f32 v67, v98, v99
  v_cvt_pk_bf16_f32 v74, v100, v101
  v_cvt_pk_bf16_f32 v75, v102, v103
  v_cvt_pk_bf16_f32 v146, v104, v105
  v_cvt_pk_bf16_f32 v147, v106, v107
  v_cvt_pk_bf16_f32 v154, v108, v109
  v_cvt_pk_bf16_f32 v155, v110, v111
  v_pk_fma_f32 v[112:113], v[28:29], v[2:3], v[112:113] op_sel_hi:[1,0,1] neg_lo:[1,0,0] neg_hi:[1,0,0]
  v_pk_fma_f32 v[114:115], v[30:31], v[2:3], v[114:115] op_sel_hi:[1,0,1] neg_lo:[1,0,0] neg_hi:[1,0,0]
  v_pk_mul_f32 v[112:113], v[112:113], v[44:45]
  v_pk_mul_f32 v[114:115], v[114:115], v[46:47]
  v_pk_fma_f32 v[116:117], v[28:29], v[4:5], v[116:117] op_sel_hi:[1,0,1] neg_lo:[1,0,0] neg_hi:[1,0,0]
  v_pk_fma_f32 v[118:119], v[30:31], v[4:5], v[118:119] op_sel_hi:[1,0,1] neg_lo:[1,0,0] neg_hi:[1,0,0]
  v_pk_mul_f32 v[116:117], v[116:117], v[44:45]
  v_pk_mul_f32 v[118:119], v[118:119], v[46:47]
  v_pk_fma_f32 v[120:121], v[28:29], v[6:7], v[120:121] op_sel_hi:[1,0,1] neg_lo:[1,0,0] neg_hi:[1,0,0]
  v_pk_fma_f32 v[122:123], v[30:31], v[6:7], v[122:123] op_sel_hi:[1,0,1] neg_lo:[1,0,0] neg_hi:[1,0,0]
  v_pk_mul_f32 v[120:121], v[120:121], v[44:45]
  v_pk_mul_f32 v[122:123], v[122:123], v[46:47]
  v_pk_fma_f32 v[124:125], v[16:17], v[56:57], v[124:125] op_sel_hi:[1,0,1] neg_lo:[0,1,0] neg_hi:[0,1,0]
  v_pk_fma_f32 v[126:127], v[18:19], v[56:57], v[126:127] op_sel_hi:[1,0,1] neg_lo:[0,1,0] neg_hi:[0,1,0]
  v_pk_mul_f32 v[124:125], v[124:125], v[56:57] op_sel:[0,1] op_sel_hi:[1,1]
  v_pk_mul_f32 v[126:127], v[126:127], v[56:57] op_sel:[0,1] op_sel_hi:[1,1]
  v_min_f32 v160, 0, v112
  v_min_f32 v161, 0, v113
  v_min_f32 v162, 0, v114
  v_min_f32 v163, 0, v115
  v_pk_mul_f32 v[160:161], v[160:161], s[54:55]
  v_pk_mul_f32 v[162:163], v[162:163], s[54:55]
  v_exp_f32 v160, v160
  v_exp_f32 v161, v161
  v_exp_f32 v162, v162
  v_exp_f32 v163, v163
  v_max_f32 v112, 0, v112
  v_max_f32 v113, 0, v113
  v_max_f32 v114, 0, v114
  v_max_f32 v115, 0, v115
  v_pk_add_f32 v[160:161], v[160:161], s[56:57]
  v_pk_add_f32 v[162:163], v[162:163], s[56:57]
  v_pk_add_f32 v[112:113], v[112:113], v[160:161]
  v_pk_add_f32 v[114:115], v[114:115], v[162:163]
  v_min_f32 v160, 0, v124
  v_min_f32 v161, 0, v125
  v_min_f32 v162, 0, v126
  v_min_f32 v163, 0, v127
  v_pk_mul_f32 v[160:161], v[160:161], s[54:55]
  v_pk_mul_f32 v[162:163], v[162:163], s[54:55]
  v_exp_f32 v160, v160
  v_exp_f32 v161, v161
  v_exp_f32 v162, v162
  v_exp_f32 v163, v163
  v_max_f32 v124, 0, v124
  v_max_f32 v125, 0, v125
  v_max_f32 v126, 0, v126
  v_max_f32 v127, 0, v127
  v_pk_add_f32 v[160:161], v[160:161], s[56:57]
  v_pk_add_f32 v[162:163], v[162:163], s[56:57]
  v_pk_add_f32 v[124:125], v[124:125], v[160:161]
  v_pk_add_f32 v[126:127], v[126:127], v[162:163]
  v_mov_b32 v164, v120
  v_mov_b32 v165, v121
  v_mov_b32 v166, v122
  v_mov_b32 v167, v123
  v_min_f32 v160, 0, v120
  v_min_f32 v161, 0, v121
  v_min_f32 v162, 0, v122
  v_min_f32 v163, 0, v123
  v_pk_mul_f32 v[160:161], v[160:161], s[54:55]
  v_pk_mul_f32 v[162:163], v[162:163], s[54:55]
  v_exp_f32 v160, v160
  v_exp_f32 v161, v161
  v_exp_f32 v162, v162
  v_exp_f32 v163, v163
  v_max_f32 v120, 0, v120
  v_max_f32 v121, 0, v121
  v_max_f32 v122, 0, v122
  v_max_f32 v123, 0, v123
  v_pk_add_f32 v[160:161], v[160:161], s[56:57]
  v_pk_add_f32 v[162:163], v[162:163], s[56:57]
  v_pk_add_f32 v[120:121], v[120:121], v[160:161]
  v_pk_add_f32 v[122:123], v[122:123], v[162:163]
  v_cndmask_b32 v120, v120, v164, s[48:49]
  v_cndmask_b32 v121, v121, v165, s[48:49]
  v_cndmask_b32 v122, v122, v166, s[48:49]
  v_cndmask_b32 v123, v123, v167, s[48:49]
  v_cvt_pk_bf16_f32 v68, v112, v113
  v_cvt_pk_bf16_f32 v69, v114, v115
  v_cvt_pk_bf16_f32 v76, v116, v117
  v_cvt_pk_bf16_f32 v77, v118, v119
  v_cvt_pk_bf16_f32 v148, v120, v121
  v_cvt_pk_bf16_f32 v149, v122, v123
  v_cvt_pk_bf16_f32 v156, v124, v125
  v_cvt_pk_bf16_f32 v157, v126, v127
  v_pk_fma_f32 v[128:129], v[32:33], v[2:3], v[128:129] op_sel_hi:[1,0,1] neg_lo:[1,0,0] neg_hi:[1,0,0]
  v_pk_fma_f32 v[130:131], v[34:35], v[2:3], v[130:131] op_sel_hi:[1,0,1] neg_lo:[1,0,0] neg_hi:[1,0,0]
  v_pk_mul_f32 v[128:129], v[128:129], v[48:49]
  v_pk_mul_f32 v[130:131], v[130:131], v[50:51]
  v_pk_fma_f32 v[132:133], v[32:33], v[4:5], v[132:133] op_sel_hi:[1,0,1] neg_lo:[1,0,0] neg_hi:[1,0,0]
  v_pk_fma_f32 v[134:135], v[34:35], v[4:5], v[134:135] op_sel_hi:[1,0,1] neg_lo:[1,0,0] neg_hi:[1,0,0]
  v_pk_mul_f32 v[132:133], v[132:133], v[48:49]
  v_pk_mul_f32 v[134:135], v[134:135], v[50:51]
  v_pk_fma_f32 v[136:137], v[32:33], v[6:7], v[136:137] op_sel_hi:[1,0,1] neg_lo:[1,0,0] neg_hi:[1,0,0]
  v_pk_fma_f32 v[138:139], v[34:35], v[6:7], v[138:139] op_sel_hi:[1,0,1] neg_lo:[1,0,0] neg_hi:[1,0,0]
  v_pk_mul_f32 v[136:137], v[136:137], v[48:49]
  v_pk_mul_f32 v[138:139], v[138:139], v[50:51]
  v_pk_fma_f32 v[140:141], v[16:17], v[58:59], v[140:141] op_sel_hi:[1,0,1] neg_lo:[0,1,0] neg_hi:[0,1,0]
  v_pk_fma_f32 v[142:143], v[18:19], v[58:59], v[142:143] op_sel_hi:[1,0,1] neg_lo:[0,1,0] neg_hi:[0,1,0]
  v_pk_mul_f32 v[140:141], v[140:141], v[58:59] op_sel:[0,1] op_sel_hi:[1,1]
  v_pk_mul_f32 v[142:143], v[142:143], v[58:59] op_sel:[0,1] op_sel_hi:[1,1]
  v_min_f32 v160, 0, v128
  v_min_f32 v161, 0, v129
  v_min_f32 v162, 0, v130
  v_min_f32 v163, 0, v131
  v_pk_mul_f32 v[160:161], v[160:161], s[54:55]
  v_pk_mul_f32 v[162:163], v[162:163], s[54:55]
  v_exp_f32 v160, v160
  v_exp_f32 v161, v161
  v_exp_f32 v162, v162
  v_exp_f32 v163, v163
  v_max_f32 v128, 0, v128
  v_max_f32 v129, 0, v129
  v_max_f32 v130, 0, v130
  v_max_f32 v131, 0, v131
  v_pk_add_f32 v[160:161], v[160:161], s[56:57]
  v_pk_add_f32 v[162:163], v[162:163], s[56:57]
  v_pk_add_f32 v[128:129], v[128:129], v[160:161]
  v_pk_add_f32 v[130:131], v[130:131], v[162:163]
  v_min_f32 v160, 0, v140
  v_min_f32 v161, 0, v141
  v_min_f32 v162, 0, v142
  v_min_f32 v163, 0, v143
  v_pk_mul_f32 v[160:161], v[160:161], s[54:55]
  v_pk_mul_f32 v[162:163], v[162:163], s[54:55]
  v_exp_f32 v160, v160
  v_exp_f32 v161, v161
  v_exp_f32 v162, v162
  v_exp_f32 v163, v163
  v_max_f32 v140, 0, v140
  v_max_f32 v141, 0, v141
  v_max_f32 v142, 0, v142
  v_max_f32 v143, 0, v143
  v_pk_add_f32 v[160:161], v[160:161], s[56:57]
  v_pk_add_f32 v[162:163], v[162:163], s[56:57]
  v_pk_add_f32 v[140:141], v[140:141], v[160:161]
  v_pk_add_f32 v[142:143], v[142:143], v[162:163]
  v_mov_b32 v164, v136
  v_mov_b32 v165, v137
  v_mov_b32 v166, v138
  v_mov_b32 v167, v139
  v_min_f32 v160, 0, v136
  v_min_f32 v161, 0, v137
  v_min_f32 v162, 0, v138
  v_min_f32 v163, 0, v139
  v_pk_mul_f32 v[160:161], v[160:161], s[54:55]
  v_pk_mul_f32 v[162:163], v[162:163], s[54:55]
  v_exp_f32 v160, v160
  v_exp_f32 v161, v161
  v_exp_f32 v162, v162
  v_exp_f32 v163, v163
  v_max_f32 v136, 0, v136
  v_max_f32 v137, 0, v137
  v_max_f32 v138, 0, v138
  v_max_f32 v139, 0, v139
  v_pk_add_f32 v[160:161], v[160:161], s[56:57]
  v_pk_add_f32 v[162:163], v[162:163], s[56:57]
  v_pk_add_f32 v[136:137], v[136:137], v[160:161]
  v_pk_add_f32 v[138:139], v[138:139], v[162:163]
  v_cndmask_b32 v136, v136, v164, s[48:49]
  v_cndmask_b32 v137, v137, v165, s[48:49]
  v_cndmask_b32 v138, v138, v166, s[48:49]
  v_cndmask_b32 v139, v139, v167, s[48:49]
  v_cvt_pk_bf16_f32 v70, v128, v129
  v_cvt_pk_bf16_f32 v71, v130, v131
  v_cvt_pk_bf16_f32 v78, v132, v133
  v_cvt_pk_bf16_f32 v79, v134, v135
  v_cvt_pk_bf16_f32 v150, v136, v137
  v_cvt_pk_bf16_f32 v151, v138, v139
  v_cvt_pk_bf16_f32 v158, v140, v141
  v_cvt_pk_bf16_f32 v159, v142, v143
  s_lshl_b32 s40, s24, 1
  s_add_u32 s40, s40, s27
  s_lshl_b32 s40, s40, 2
  s_lshr_b32 s41, s25, 2
  s_add_u32 s40, s40, s41
  s_mul_i32 s40, s40, 21504
  s_and_b32 s41, s25, 3
  s_mul_i32 s41, s41, 80
  s_add_u32 s41, s41, s40
  s_movk_i32 s42, 336
  v_mul_u32_u24 v10, s42, v8
  v_lshl_add_u32 v10, v9, 3, v10
  s_lshl_b32 s43, s28, 5
  s_add_u32 s43, s43, s41
  s_add_u32 s47, s43, 18169856
  buffer_store_dwordx2 v[152:153], v10, s[16:19], s47 offen
  s_add_u32 s47, s43, 18175232
  buffer_store_dwordx2 v[154:155], v10, s[16:19], s47 offen
  s_add_u32 s47, s43, 18180608
  buffer_store_dwordx2 v[156:157], v10, s[16:19], s47 offen
  s_add_u32 s47, s43, 18185984
  buffer_store_dwordx2 v[158:159], v10, s[16:19], s47 offen
  v_mov_b32 v160, 0x3f803f80
  v_mov_b32 v161, 0x3f803f80
  v_mov_b32 v162, 0x3f803f80
  v_mov_b32 v163, 0x3f803f80
  s_nop 1
  v_mfma_f32_16x16x32_bf16 v[80:83], v[64:67], v[72:75], 0
  v_mfma_f32_16x16x32_bf16 v[84:87], v[64:67], v[144:147], 0
  v_mfma_f32_16x16x32_bf16 v[88:91], v[144:147], v[72:75], 0
  v_mfma_f32_16x16x32_bf16 v[92:95], v[144:147], v[144:147], 0
  v_mfma_f32_16x16x32_bf16 v[96:99], v[64:67], v[160:163], 0
  v_mfma_f32_16x16x32_bf16 v[100:103], v[144:147], v[160:163], 0
  v_mfma_f32_16x16x32_bf16 v[80:83], v[68:71], v[76:79], v[80:83]
  v_mfma_f32_16x16x32_bf16 v[84:87], v[68:71], v[148:151], v[84:87]
  v_mfma_f32_16x16x32_bf16 v[88:91], v[148:151], v[76:79], v[88:91]
  v_mfma_f32_16x16x32_bf16 v[92:95], v[148:151], v[148:151], v[92:95]
  v_mfma_f32_16x16x32_bf16 v[96:99], v[68:71], v[160:163], v[96:99]
  v_mfma_f32_16x16x32_bf16 v[100:103], v[148:151], v[160:163], v[100:103]
  s_cmp_eq_u32 s28, 1
  s_cbranch_scc1 L1_noq2
  v_lshlrev_b32 v11, 2, v9
  v_mul_u32_u24 v11, s42, v11
  v_lshl_add_u32 v11, v8, 1, v11
  v_cmp_lt_u32 vcc, 7, v8
  s_and_saveexec_b64 s[50:51], vcc
  s_add_u32 s47, s41, 18169904
  buffer_store_short v144, v11, s[16:19], s47 offen
  buffer_store_short_d16_hi v144, v11, s[16:19], s47 offen offset:336
  buffer_store_short v145, v11, s[16:19], s47 offen offset:672
  buffer_store_short_d16_hi v145, v11, s[16:19], s47 offen offset:1008
  s_add_u32 s47, s41, 18175280
  buffer_store_short v146, v11, s[16:19], s47 offen
  buffer_store_short_d16_hi v146, v11, s[16:19], s47 offen offset:336
  buffer_store_short v147, v11, s[16:19], s47 offen offset:672
  buffer_store_short_d16_hi v147, v11, s[16:19], s47 offen offset:1008
  s_add_u32 s47, s41, 18180656
  buffer_store_short v148, v11, s[16:19], s47 offen
  buffer_store_short_d16_hi v148, v11, s[16:19], s47 offen offset:336
  buffer_store_short v149, v11, s[16:19], s47 offen offset:672
  buffer_store_short_d16_hi v149, v11, s[16:19], s47 offen offset:1008
  s_add_u32 s47, s41, 18186032
  buffer_store_short v150, v11, s[16:19], s47 offen
  buffer_store_short_d16_hi v150, v11, s[16:19], s47 offen offset:336
  buffer_store_short v151, v11, s[16:19], s47 offen offset:672
  buffer_store_short_d16_hi v151, v11, s[16:19], s47 offen offset:1008
  s_mov_b64 exec, s[50:51]
L1_noq2:
  s_lshl_b32 s40, s25, 2
  v_mov_b32 v11, s40
  s_mul_i32 s40, s28, 1680
  s_add_u32 s40, s40, 135168
  v_mul_u32_u24 v10, 80, v8
  v_lshl_add_u32 v10, v9, 4, v10
  v_add_u32 v10, s40, v10
  s_lshl_b32 s41, s27, 12
  v_add_u32 v10, s41, v10
  s_nop 4
  ds_write_b128 v10, v[80:83]
  s_mov_b64 exec, s[48:49]
  ds_write_b128 v10, v[84:87] offset:960
  s_mov_b64 exec, 0xffff
  ds_write_b128 v10, v[88:91] offset:64
  s_mov_b64 exec, 0xf0
  ds_write_b128 v10, v[92:95] offset:1024
  s_mov_b32 s50, 0x00010001
  s_mov_b32 s51, 0x00010001
  s_mov_b64 exec, s[50:51]
  ds_write_b128 v10, v[96:99] offset:1600
  s_mov_b64 exec, 1
  ds_write_b128 v10, v[100:103] offset:1664
  s_cmp_lg_u32 s26, 0
  s_cbranch_scc1 L1_nopoll
L1_poll:
  buffer_load_dword v12, v11, s[20:23], 0 offen sc0 sc1
  s_waitcnt vmcnt(0)
  v_readfirstlane_b32 s41, v12
  s_nop 3
  s_cmp_lt_u32 s41, 4
  s_cbranch_scc1 L1_poll
L1_nopoll:
  s_mov_b64 exec, -1
  s_waitcnt lgkmcnt(0)
  s_barrier
  v_lshl_or_b32 v11, s26, 6, v0
  v_lshlrev_b32 v11, 2, v11
  v_add_u32 v12, 135168, v11
  ds_read_b32 v160, v12 offset:0
  ds_read_b32 v164, v12 offset:4096
  ds_read_b32 v161, v12 offset:1024
  ds_read_b32 v165, v12 offset:5120
  ds_read_b32 v162, v12 offset:2048
  ds_read_b32 v166, v12 offset:6144
  ds_read_b32 v163, v12 offset:3072
  ds_read_b32 v167, v12 offset:7168
  s_mul_i32 s40, s25, 3360
  s_add_u32 s40, s40, 2621440
  s_waitcnt lgkmcnt(0)
  v_add_f32 v160, v160, v164
  v_add_f32 v161, v161, v165
  v_add_f32 v162, v162, v166
  v_add_f32 v163, v163, v167
  buffer_atomic_add_f32 v160, v11, s[16:19], s40 offen offset:0
  buffer_atomic_add_f32 v161, v11, s[16:19], s40 offen offset:1024
  buffer_atomic_add_f32 v162, v11, s[16:19], s40 offen offset:2048
  v_cmp_gt_u32 vcc, 288, v11
  s_and_saveexec_b64 s[50:51], vcc
  s_cbranch_execz L1_fin
  buffer_atomic_add_f32 v163, v11, s[16:19], s40 offen offset:3072
L1_fin:
  s_branch L1_done
L1_loader:
  s_sub_u32 s27, s26, 4
  v_lshrrev_b32 v8, 3, v0
  v_and_b32 v9, 7, v0
  v_xor_b32 v9, v9, v8
  v_lshlrev_b32 v9, 4, v9
  s_lshl_b32 s40, s24, 7
  s_lshl_b32 s41, s27, 4
  s_add_u32 s40, s40, s41
  v_add_u32 v8, s40, v8
  s_movk_i32 s41, 1280
  v_mad_u32_u24 v2, v8, s41, v9
  v_add_u32 v3, 9216, v2
  v_lshrrev_b32 v8, 4, v0
  v_and_b32 v9, 15, v0
  s_lshl_b32 s40, s27, 3
  v_add_u32 v12, s40, v8
  s_and_b32 s40, s27, 1
  s_lshl_b32 s40, s40, 2
  v_add_u32 v8, s40, v8
  v_lshrrev_b32 v10, 1, v9
  v_xor_b32 v10, v10, v8
  v_lshlrev_b32 v10, 1, v10
  v_and_b32 v11, 1, v9
  v_or_b32 v10, v10, v11
  v_min_u32 v10, 14, v10
  v_lshlrev_b32 v11, 4, v10
  v_add_u32 v20, 1280, v11
  v_add_u32 v21, 2480, v11
  v_subrev_u32 v22, 160, v11
  v_cmp_gt_u32 vcc, 5, v10
  s_nop 1
  v_cndmask_b32 v21, v21, v20, vcc
  v_cmp_gt_u32 vcc, 10, v10
  s_nop 1
  v_cndmask_b32 v11, v22, v21, vcc
  s_mul_i32 s42, s25, 80
  v_add_u32 v11, s42, v11
  s_movk_i32 s41, 3840
  v_mad_u32_u24 v4, v12, s41, v11
  v_add_u32 v5, 14336, v4
  s_lshl_b32 s34, s27, 11
  s_mov_b32 s31, 0
  s_mov_b32 s32, 0
  s_mov_b32 s33, 0
  s_mul_i32 s40, s24, 3
  s_add_u32 s40, s40, s25
  s_mul_i32 s41, s40, 205
  s_lshr_b32 s41, s41, 11
  s_mul_i32 s41, s41, 10
  s_sub_u32 s40, s40, s41
  s_lshl_b32 s32, s40, 7
  s_mul_i32 s33, s40, 245760
  s_add_u32 s35, s31, s34
  s_mov_b32 m0, s35
  s_add_u32 s35, s35, 16384
  buffer_load_dwordx4 v2, s[8:11], s32 offen offset:0 lds
  buffer_load_dwordx4 v3, s[8:11], s32 offen offset:1024 lds
  s_mov_b32 m0, s35
  s_add_u32 s32, s32, 128
  buffer_load_dwordx4 v4, s[12:15], s33 offen offset:0 lds
  buffer_load_dwordx4 v5, s[12:15], s33 offen offset:1024 lds
  s_add_u32 s33, s33, 245760
  s_cmp_eq_u32 s32, 1280
  s_cselect_b32 s32, 0, s32
  s_cselect_b32 s33, 0, s33
  s_add_u32 s31, s31, 32768
  s_cmp_eq_u32 s31, 131072
  s_cselect_b32 s31, 0, s31
  s_add_u32 s35, s31, s34
  s_mov_b32 m0, s35
  s_add_u32 s35, s35, 16384
  buffer_load_dwordx4 v2, s[8:11], s32 offen offset:0 lds
  buffer_load_dwordx4 v3, s[8:11], s32 offen offset:1024 lds
  s_mov_b32 m0, s35
  s_add_u32 s32, s32, 128
  buffer_load_dwordx4 v4, s[12:15], s33 offen offset:0 lds
  buffer_load_dwordx4 v5, s[12:15], s33 offen offset:1024 lds
  s_add_u32 s33, s33, 245760
  s_cmp_eq_u32 s32, 1280
  s_cselect_b32 s32, 0, s32
  s_cselect_b32 s33, 0, s33
  s_add_u32 s31, s31, 32768
  s_cmp_eq_u32 s31, 131072
  s_cselect_b32 s31, 0, s31
  s_add_u32 s35, s31, s34
  s_mov_b32 m0, s35
  s_add_u32 s35, s35, 16384
  buffer_load_dwordx4 v2, s[8:11], s32 offen offset:0 lds
  buffer_load_dwordx4 v3, s[8:11], s32 offen offset:1024 lds
  s_mov_b32 m0, s35
  s_add_u32 s32, s32, 128
  buffer_load_dwordx4 v4, s[12:15], s33 offen offset:0 lds
  buffer_load_dwordx4 v5, s[12:15], s33 offen offset:1024 lds
  s_add_u32 s33, s33, 245760
  s_cmp_eq_u32 s32, 1280
  s_cselect_b32 s32, 0, s32
  s_cselect_b32 s33, 0, s33
  s_add_u32 s31, s31, 32768
  s_cmp_eq_u32 s31, 131072
  s_cselect_b32 s31, 0, s31
  s_add_u32 s35, s31, s34
  s_mov_b32 m0, s35
  s_add_u32 s35, s35, 16384
  buffer_load_dwordx4 v2, s[8:11], s32 offen offset:0 lds
  buffer_load_dwordx4 v3, s[8:11], s32 offen offset:1024 lds
  s_mov_b32 m0, s35
  s_add_u32 s32, s32, 128
  buffer_load_dwordx4 v4, s[12:15], s33 offen offset:0 lds
  buffer_load_dwordx4 v5, s[12:15], s33 offen offset:1024 lds
  s_add_u32 s33, s33, 245760
  s_cmp_eq_u32 s32, 1280
  s_cselect_b32 s32, 0, s32
  s_cselect_b32 s33, 0, s33
  s_add_u32 s31, s31, 32768
  s_cmp_eq_u32 s31, 131072
  s_cselect_b32 s31, 0, s31

L1_PFRET:
  s_mov_b64 exec, -1
  s_waitcnt vmcnt(12)
  s_barrier
  s_waitcnt vmcnt(8)
  s_barrier
  s_add_u32 s35, s31, s34
  s_mov_b32 m0, s35
  s_add_u32 s35, s35, 16384
  buffer_load_dwordx4 v2, s[8:11], s32 offen offset:0 lds
  buffer_load_dwordx4 v3, s[8:11], s32 offen offset:1024 lds
  s_mov_b32 m0, s35
  s_add_u32 s32, s32, 128
  buffer_load_dwordx4 v4, s[12:15], s33 offen offset:0 lds
  buffer_load_dwordx4 v5, s[12:15], s33 offen offset:1024 lds
  s_add_u32 s33, s33, 245760
  s_cmp_eq_u32 s32, 1280
  s_cselect_b32 s32, 0, s32
  s_cselect_b32 s33, 0, s33
  s_add_u32 s31, s31, 32768
  s_cmp_eq_u32 s31, 131072
  s_cselect_b32 s31, 0, s31
  s_waitcnt vmcnt(8)
  s_barrier
  s_add_u32 s35, s31, s34
  s_mov_b32 m0, s35
  s_add_u32 s35, s35, 16384
  buffer_load_dwordx4 v2, s[8:11], s32 offen offset:0 lds
  buffer_load_dwordx4 v3, s[8:11], s32 offen offset:1024 lds
  s_mov_b32 m0, s35
  s_add_u32 s32, s32, 128
  buffer_load_dwordx4 v4, s[12:15], s33 offen offset:0 lds
  buffer_load_dwordx4 v5, s[12:15], s33 offen offset:1024 lds
  s_add_u32 s33, s33, 245760
  s_cmp_eq_u32 s32, 1280
  s_cselect_b32 s32, 0, s32
  s_cselect_b32 s33, 0, s33
  s_add_u32 s31, s31, 32768
  s_cmp_eq_u32 s31, 131072
  s_cselect_b32 s31, 0, s31
  s_waitcnt vmcnt(8)
  s_barrier
  s_add_u32 s35, s31, s34
  s_mov_b32 m0, s35
  s_add_u32 s35, s35, 16384
  buffer_load_dwordx4 v2, s[8:11], s32 offen offset:0 lds
  buffer_load_dwordx4 v3, s[8:11], s32 offen offset:1024 lds
  s_mov_b32 m0, s35
  s_add_u32 s32, s32, 128
  buffer_load_dwordx4 v4, s[12:15], s33 offen offset:0 lds
  buffer_load_dwordx4 v5, s[12:15], s33 offen offset:1024 lds
  s_add_u32 s33, s33, 245760
  s_cmp_eq_u32 s32, 1280
  s_cselect_b32 s32, 0, s32
  s_cselect_b32 s33, 0, s33
  s_add_u32 s31, s31, 32768
  s_cmp_eq_u32 s31, 131072
  s_cselect_b32 s31, 0, s31
  s_waitcnt vmcnt(8)
  s_barrier
  s_add_u32 s35, s31, s34
  s_mov_b32 m0, s35
  s_add_u32 s35, s35, 16384
  buffer_load_dwordx4 v2, s[8:11], s32 offen offset:0 lds
  buffer_load_dwordx4 v3, s[8:11], s32 offen offset:1024 lds
  s_mov_b32 m0, s35
  s_add_u32 s32, s32, 128
  buffer_load_dwordx4 v4, s[12:15], s33 offen offset:0 lds
  buffer_load_dwordx4 v5, s[12:15], s33 offen offset:1024 lds
  s_add_u32 s33, s33, 245760
  s_cmp_eq_u32 s32, 1280
  s_cselect_b32 s32, 0, s32
  s_cselect_b32 s33, 0, s33
  s_add_u32 s31, s31, 32768
  s_cmp_eq_u32 s31, 131072
  s_cselect_b32 s31, 0, s31
  s_waitcnt vmcnt(8)
  s_barrier
  s_add_u32 s35, s31, s34
  s_mov_b32 m0, s35
  s_add_u32 s35, s35, 16384
  buffer_load_dwordx4 v2, s[8:11], s32 offen offset:0 lds
  buffer_load_dwordx4 v3, s[8:11], s32 offen offset:1024 lds
  s_mov_b32 m0, s35
  s_add_u32 s32, s32, 128
  buffer_load_dwordx4 v4, s[12:15], s33 offen offset:0 lds
  buffer_load_dwordx4 v5, s[12:15], s33 offen offset:1024 lds
  s_add_u32 s33, s33, 245760
  s_cmp_eq_u32 s32, 1280
  s_cselect_b32 s32, 0, s32
  s_cselect_b32 s33, 0, s33
  s_add_u32 s31, s31, 32768
  s_cmp_eq_u32 s31, 131072
  s_cselect_b32 s31, 0, s31
  s_waitcnt vmcnt(8)
  s_barrier
  s_add_u32 s35, s31, s34
  s_mov_b32 m0, s35
  s_add_u32 s35, s35, 16384
  buffer_load_dwordx4 v2, s[8:11], s32 offen offset:0 lds
  buffer_load_dwordx4 v3, s[8:11], s32 offen offset:1024 lds
  s_mov_b32 m0, s35
  s_add_u32 s32, s32, 128
  buffer_load_dwordx4 v4, s[12:15], s33 offen offset:0 lds
  buffer_load_dwordx4 v5, s[12:15], s33 offen offset:1024 lds
  s_add_u32 s33, s33, 245760
  s_cmp_eq_u32 s32, 1280
  s_cselect_b32 s32, 0, s32
  s_cselect_b32 s33, 0, s33
  s_add_u32 s31, s31, 32768
  s_cmp_eq_u32 s31, 131072
  s_cselect_b32 s31, 0, s31
  s_load_dwordx2 s[64:65], s[0:1], 32
  s_load_dwordx2 s[66:67], s[0:1], 40
  s_load_dwordx2 s[68:69], s[0:1], 16
  v_lshl_or_b32 v59, s27, 6, v0
  v_mov_b32 v32, 0
  v_mov_b32 v33, 0
  v_mov_b32 v34, 0
  v_mov_b32 v35, 0
  v_mov_b32 v36, 0
  v_mov_b32 v37, 0
  v_mov_b32 v38, 0
  v_mov_b32 v39, 0
  v_mov_b32 v40, 0
  v_mov_b32 v41, 0
  v_mov_b32 v42, 0
  v_mov_b32 v43, 0
  v_mov_b32 v44, 0
  v_mov_b32 v45, 0
  v_mov_b32 v46, 0
  v_mov_b32 v47, 0
  v_mov_b32 v48, 0
  v_mov_b32 v49, 0
  v_mov_b32 v50, 0
  v_mov_b32 v51, 0
  s_lshr_b32 s40, s2, 4
  s_and_b32 s41, s2, 15
  s_mul_i32 s41, s41, 40
  s_mul_i32 s42, s40, 224
  s_movk_i32 s43, 3456
  v_add_u32 v60, 0, v59
  v_lshrrev_b32 v61, 4, v60
  v_add_u32 v61, s41, v61
  v_and_b32 v62, 15, v60
  v_bfe_u32 v63, v61, 3, 1
  v_lshlrev_b32 v63, 2, v63
  v_and_or_b32 v63, v61, 3, v63
  v_lshrrev_b32 v24, 1, v62
  v_xor_b32 v63, v63, v24
  v_and_b32 v24, 1, v62
  v_lshl_or_b32 v63, v63, 1, v24
  v_lshlrev_b32 v24, 8, v61
  v_lshl_add_u32 v24, v63, 4, v24
  v_lshl_add_u32 v63, v62, 4, s42
  v_mad_u32_u24 v16, v61, s43, v63
  v_cmp_gt_u32 s[80:81], 14, v62
  v_cmp_gt_u32 vcc, s43, v63
  s_and_b64 s[80:81], s[80:81], vcc
  v_cmp_gt_u32 vcc, 640, v60
  s_mov_b64 s[70:71], vcc
  s_and_b64 s[80:81], s[80:81], vcc
  v_add_u32 v60, 512, v59
  v_lshrrev_b32 v61, 4, v60
  v_add_u32 v61, s41, v61
  v_and_b32 v62, 15, v60
  v_bfe_u32 v63, v61, 3, 1
  v_lshlrev_b32 v63, 2, v63
  v_and_or_b32 v63, v61, 3, v63
  v_lshrrev_b32 v25, 1, v62
  v_xor_b32 v63, v63, v25
  v_and_b32 v25, 1, v62
  v_lshl_or_b32 v63, v63, 1, v25
  v_lshlrev_b32 v25, 8, v61
  v_lshl_add_u32 v25, v63, 4, v25
  v_lshl_add_u32 v63, v62, 4, s42
  v_mad_u32_u24 v17, v61, s43, v63
  v_cmp_gt_u32 s[82:83], 14, v62
  v_cmp_gt_u32 vcc, s43, v63
  s_and_b64 s[82:83], s[82:83], vcc
  v_cmp_gt_u32 vcc, 640, v60
  s_mov_b64 s[72:73], vcc
  s_and_b64 s[82:83], s[82:83], vcc
  s_lshr_b32 s40, s2, 5
  s_and_b32 s41, s2, 31
  s_movk_i32 s43, 6554
  s_mul_i32 s42, s40, 160
  v_add_u32 v60, 0, v59
  v_mul_u32_u24 v61, s43, v60
  v_lshrrev_b32 v61, 16, v61
  v_mul_u32_u24 v62, 10, v61
  v_sub_u32 v62, v60, v62
  s_mul_i32 s47, s41, 54
  v_add_u32 v61, s47, v61
  v_lshlrev_b32 v62, 4, v62
  v_mul_u32_u24 v18, 1280, v61
  v_add_u32 v18, v18, v62
  v_add_u32 v18, s42, v18
  v_and_b32 v63, 0x13, v61
  v_bfe_u32 v26, v61, 2, 1
  v_lshl_or_b32 v63, v26, 3, v63
  v_bfe_u32 v26, v61, 3, 1
  v_lshl_or_b32 v63, v26, 2, v63
  v_mul_u32_u24 v63, 160, v63
  v_lshrrev_b32 v26, 5, v61
  v_mul_u32_u24 v26, 5120, v26
  v_add_u32 v26, v26, v63
  v_add_u32 v26, v26, v62
  v_cmp_gt_u32 vcc, 540, v60
  s_mov_b64 s[74:75], vcc
  v_add_u32 v60, 512, v59
  v_mul_u32_u24 v61, s43, v60
  v_lshrrev_b32 v61, 16, v61
  v_mul_u32_u24 v62, 10, v61
  v_sub_u32 v62, v60, v62
  s_mul_i32 s47, s41, 54
  v_add_u32 v61, s47, v61
  v_lshlrev_b32 v62, 4, v62
  v_mul_u32_u24 v19, 1280, v61
  v_add_u32 v19, v19, v62
  v_add_u32 v19, s42, v19
  v_and_b32 v63, 0x13, v61
  v_bfe_u32 v27, v61, 2, 1
  v_lshl_or_b32 v63, v27, 3, v63
  v_bfe_u32 v27, v61, 3, 1
  v_lshl_or_b32 v63, v27, 2, v63
  v_mul_u32_u24 v63, 160, v63
  v_lshrrev_b32 v27, 5, v61
  v_mul_u32_u24 v27, 5120, v27
  v_add_u32 v27, v27, v63
  v_add_u32 v27, v27, v62
  v_cmp_gt_u32 vcc, 540, v60
  s_mov_b64 s[76:77], vcc
  v_add_u32 v60, 0, v59
  v_mul_u32_u24 v61, s43, v60
  v_lshrrev_b32 v61, 16, v61
  v_mul_u32_u24 v62, 10, v61
  v_sub_u32 v62, v60, v62
  s_mul_i32 s47, s41, 20
  v_add_u32 v61, s47, v61
  v_lshlrev_b32 v62, 4, v62
  v_mul_u32_u24 v20, 1280, v61
  v_add_u32 v20, v20, v62
  v_add_u32 v20, s42, v20
  v_mul_u32_u24 v28, 160, v61
  v_add_u32 v28, v28, v62
  v_cmp_gt_u32 vcc, 200, v60
  s_mov_b64 s[78:79], vcc
  s_waitcnt lgkmcnt(0)
  s_mov_b32 s84, s64
  s_mov_b32 s85, s65
  s_mov_b32 s86, 2211840
  s_mov_b32 s87, 0x00020000
  s_mov_b32 s88, s66
  s_mov_b32 s89, s67
  s_mov_b32 s90, 2211840
  s_mov_b32 s91, 0x00020000
  s_mov_b32 s92, s68
  s_mov_b32 s93, s69
  s_mov_b32 s94, 819200
  s_mov_b32 s95, 0x00020000
  v_cndmask_b32 v16, 0, v16, s[80:81]
  buffer_load_dwordx4 v[32:35], v16, s[84:87], 0 offen
  v_cndmask_b32 v17, 0, v17, s[82:83]
  buffer_load_dwordx4 v[36:39], v17, s[84:87], 0 offen
  v_cndmask_b32 v18, 0, v18, s[74:75]
  buffer_load_dwordx4 v[40:43], v18, s[88:91], 0 offen
  v_cndmask_b32 v19, 0, v19, s[76:77]
  buffer_load_dwordx4 v[44:47], v19, s[88:91], 0 offen
  v_cndmask_b32 v20, 0, v20, s[78:79]
  buffer_load_dwordx4 v[48:51], v20, s[92:95], 0 offen
  s_waitcnt vmcnt(13)
  s_barrier
  s_waitcnt vmcnt(9)
  s_barrier
  s_waitcnt vmcnt(5)
  s_barrier
  s_mov_b32 s16, s38
  s_mov_b32 s17, s39
  s_mov_b32 s18, 21053440
  s_mov_b32 s19, 0x00020000
  s_lshr_b32 s40, s2, 5
  s_lshr_b32 s41, s2, 4
  s_mul_i32 s41, s41, 163840
  s_add_u32 s41, s41, 12517376
  s_mul_i32 s42, s40, 276480
  s_add_u32 s42, s42, 15138816
  s_mul_i32 s43, s40, 102400
  s_add_u32 s43, s43, 17350656
  s_waitcnt vmcnt(0)
  s_mov_b64 exec, s[70:71]
  s_cbranch_execz LRS0
  buffer_store_dwordx4 v[32:35], v24, s[16:19], s41 offen sc0 sc1
LRS0:
  s_mov_b64 exec, s[72:73]
  s_cbranch_execz LRS1
  buffer_store_dwordx4 v[36:39], v25, s[16:19], s41 offen sc0 sc1
LRS1:
  s_mov_b64 exec, s[74:75]
  s_cbranch_execz LRS2
  buffer_store_dwordx4 v[40:43], v26, s[16:19], s42 offen sc0 sc1
LRS2:
  s_mov_b64 exec, s[76:77]
  s_cbranch_execz LRS3
  buffer_store_dwordx4 v[44:47], v27, s[16:19], s42 offen sc0 sc1
LRS3:
  s_mov_b64 exec, s[78:79]
  s_cbranch_execz LRS4
  buffer_store_dwordx4 v[48:51], v28, s[16:19], s43 offen sc0 sc1
LRS4:
  s_mov_b64 exec, -1
  v_cndmask_b32 v36, 0, v36, s[72:73]
  v_cndmask_b32 v37, 0, v37, s[72:73]
  v_cndmask_b32 v38, 0, v38, s[72:73]
  v_cndmask_b32 v39, 0, v39, s[72:73]
  v_lshlrev_b32 v60, 16, v32
  v_and_b32 v61, 0xffff0000, v32
  v_mov_b32 v64, v60
  v_mov_b32 v65, v61
  v_lshlrev_b32 v60, 16, v36
  v_and_b32 v61, 0xffff0000, v36
  v_pk_add_f32 v[64:65], v[64:65], v[60:61]
  v_lshlrev_b32 v60, 16, v33
  v_and_b32 v61, 0xffff0000, v33
  v_mov_b32 v66, v60
  v_mov_b32 v67, v61
  v_lshlrev_b32 v60, 16, v37
  v_and_b32 v61, 0xffff0000, v37
  v_pk_add_f32 v[66:67], v[66:67], v[60:61]
  v_lshlrev_b32 v60, 16, v34
  v_and_b32 v61, 0xffff0000, v34
  v_mov_b32 v68, v60
  v_mov_b32 v69, v61
  v_lshlrev_b32 v60, 16, v38
  v_and_b32 v61, 0xffff0000, v38
  v_pk_add_f32 v[68:69], v[68:69], v[60:61]
  v_lshlrev_b32 v60, 16, v35
  v_and_b32 v61, 0xffff0000, v35
  v_mov_b32 v70, v60
  v_mov_b32 v71, v61
  v_lshlrev_b32 v60, 16, v39
  v_and_b32 v61, 0xffff0000, v39
  v_pk_add_f32 v[70:71], v[70:71], v[60:61]
  v_mov_b32 v62, v64
  s_nop 1
  v_permlane32_swap_b32 v64, v62
  s_nop 1
  v_add_f32 v64, v64, v62
  v_mov_b32 v62, v64
  s_nop 1
  v_permlane16_swap_b32 v64, v62
  s_nop 1
  v_add_f32 v64, v64, v62
  v_mov_b32 v62, v65
  s_nop 1
  v_permlane32_swap_b32 v65, v62
  s_nop 1
  v_add_f32 v65, v65, v62
  v_mov_b32 v62, v65
  s_nop 1
  v_permlane16_swap_b32 v65, v62
  s_nop 1
  v_add_f32 v65, v65, v62
  v_mov_b32 v62, v66
  s_nop 1
  v_permlane32_swap_b32 v66, v62
  s_nop 1
  v_add_f32 v66, v66, v62
  v_mov_b32 v62, v66
  s_nop 1
  v_permlane16_swap_b32 v66, v62
  s_nop 1
  v_add_f32 v66, v66, v62
  v_mov_b32 v62, v67
  s_nop 1
  v_permlane32_swap_b32 v67, v62
  s_nop 1
  v_add_f32 v67, v67, v62
  v_mov_b32 v62, v67
  s_nop 1
  v_permlane16_swap_b32 v67, v62
  s_nop 1
  v_add_f32 v67, v67, v62
  v_mov_b32 v62, v68
  s_nop 1
  v_permlane32_swap_b32 v68, v62
  s_nop 1
  v_add_f32 v68, v68, v62
  v_mov_b32 v62, v68
  s_nop 1
  v_permlane16_swap_b32 v68, v62
  s_nop 1
  v_add_f32 v68, v68, v62
  v_mov_b32 v62, v69
  s_nop 1
  v_permlane32_swap_b32 v69, v62
  s_nop 1
  v_add_f32 v69, v69, v62
  v_mov_b32 v62, v69
  s_nop 1
  v_permlane16_swap_b32 v69, v62
  s_nop 1
  v_add_f32 v69, v69, v62
  v_mov_b32 v62, v70
  s_nop 1
  v_permlane32_swap_b32 v70, v62
  s_nop 1
  v_add_f32 v70, v70, v62
  v_mov_b32 v62, v70
  s_nop 1
  v_permlane16_swap_b32 v70, v62
  s_nop 1
  v_add_f32 v70, v70, v62
  v_mov_b32 v62, v71
  s_nop 1
  v_permlane32_swap_b32 v71, v62
  s_nop 1
  v_add_f32 v71, v71, v62
  v_mov_b32 v62, v71
  s_nop 1
  v_permlane16_swap_b32 v71, v62
  s_nop 1
  v_add_f32 v71, v71, v62
  v_and_b32 v60, 15, v0
  v_lshlrev_b32 v60, 5, v60
  s_lshl_b32 s40, s27, 9
  s_add_u32 s40, s40, 143360
  v_add_u32 v60, s40, v60
  ds_write_b128 v60, v[64:67]
  ds_write_b128 v60, v[68:71] offset:16
  s_waitcnt lgkmcnt(0)
  s_barrier
  s_cmp_ge_u32 s27, 2
  s_cbranch_scc1 L1_rf2
  v_lshl_or_b32 v60, s27, 6, v0
  v_lshlrev_b32 v60, 2, v60
  v_add_u32 v61, 143360, v60
  ds_read_b32 v40, v61 offset:0
  ds_read_b32 v41, v61 offset:512
  ds_read_b32 v42, v61 offset:1024
  ds_read_b32 v43, v61 offset:1536
  ds_read_b32 v44, v61 offset:2048
  ds_read_b32 v45, v61 offset:2560
  ds_read_b32 v46, v61 offset:3072
  ds_read_b32 v47, v61 offset:3584
  s_waitcnt lgkmcnt(0)
  v_add_f32 v40, v40, v41
  v_add_f32 v40, v40, v42
  v_add_f32 v40, v40, v43
  v_add_f32 v40, v40, v44
  v_add_f32 v40, v40, v45
  v_add_f32 v40, v40, v46
  v_add_f32 v40, v40, v47
  s_lshl_b32 s40, s2, 9
  s_add_u32 s40, s40, 20922368
  buffer_store_dword v40, v60, s[16:19], s40 offen
L1_rf2:
  s_barrier
L1_done:
  s_endpgm
.globl k2_attn_kernel
.p2align 8
.type k2_attn_kernel,@function
k2_attn_kernel:
  s_cmp_ge_u32 s2, 256
  s_cbranch_scc1 L2_done
  s_load_dwordx4 s[36:39], s[0:1], 56
  s_load_dwordx2 s[4:5], s[0:1], 48
  s_load_dwordx2 s[6:7], s[0:1], 16
  s_load_dwordx2 s[42:43], s[0:1], 0
  s_and_b32 s40, s2, 7
  s_lshr_b32 s41, s2, 3
  s_lshr_b32 s24, s40, 1
  s_lshl_b32 s24, s24, 3
  s_and_b32 s44, s41, 7
  s_add_u32 s24, s24, s44
  s_and_b32 s25, s40, 1
  s_lshl_b32 s25, s25, 2
  s_lshr_b32 s44, s41, 3
  s_add_u32 s25, s25, s44
  v_lshrrev_b32 v1, 6, v0
  v_mov_b32 v2, v0
  v_and_b32 v0, 63, v0
  v_readfirstlane_b32 s26, v1
  s_nop 3
  s_and_b32 s27, s26, 3
  s_lshr_b32 s33, s26, 2
  s_mul_i32 s34, s27, 40960
  v_lshlrev_b32 v8, 4, v0
  s_lshl_b32 s40, s24, 2
  s_add_u32 s40, s40, s27
  s_mul_i32 s44, s40, 21504
  s_mul_i32 s45, s33, 11264
  s_add_u32 s44, s44, s45
  s_add_u32 s35, s34, s45
  s_mov_b32 m0, s35
  s_waitcnt lgkmcnt(0)
  s_add_u32 s8, s38, 18169856
  s_addc_u32 s9, s39, 0
  s_mov_b32 s10, 2752512
  s_mov_b32 s11, 0x00020000
  s_add_u32 s28, s38, 2621440
  s_addc_u32 s29, s39, 0
  s_mov_b32 s30, 53760
  s_mov_b32 s31, 0x00020000
  s_add_u32 s12, s38, 17350656
  s_addc_u32 s13, s39, 0
  s_mov_b32 s14, 819200
  s_mov_b32 s15, 0x00020000
  s_mul_i32 s46, s27, 13440
  s_mul_i32 s45, s33, 7168
  s_add_u32 s46, s46, s45
  s_add_u32 s35, s34, 21504
  s_add_u32 s45, s45, s35
  s_mov_b32 s47, m0
  s_mov_b32 m0, s45
  s_nop 0
  buffer_load_dwordx4 v8, s[28:31], s46 offen lds
  s_add_u32 m0, m0, 1024
  s_add_u32 s46, s46, 1024
  buffer_load_dwordx4 v8, s[28:31], s46 offen lds
  s_add_u32 m0, m0, 1024
  s_add_u32 s46, s46, 1024
  buffer_load_dwordx4 v8, s[28:31], s46 offen lds
  s_add_u32 m0, m0, 1024
  s_add_u32 s46, s46, 1024
  buffer_load_dwordx4 v8, s[28:31], s46 offen lds
  s_add_u32 m0, m0, 1024
  s_add_u32 s46, s46, 1024
  buffer_load_dwordx4 v8, s[28:31], s46 offen lds
  s_add_u32 m0, m0, 1024
  s_add_u32 s46, s46, 1024
  buffer_load_dwordx4 v8, s[28:31], s46 offen lds
  s_add_u32 m0, m0, 1024
  s_add_u32 s46, s46, 1024
  buffer_load_dwordx4 v8, s[28:31], s46 offen lds
  s_add_u32 m0, m0, 1024
  s_add_u32 s46, s46, 1024
  s_mov_b32 m0, s47
  s_nop 0
  buffer_load_dwordx4 v8, s[8:11], s44 offen lds
  s_add_u32 m0, m0, 1024
  s_add_u32 s44, s44, 1024
  buffer_load_dwordx4 v8, s[8:11], s44 offen lds
  s_add_u32 m0, m0, 1024
  s_add_u32 s44, s44, 1024
  buffer_load_dwordx4 v8, s[8:11], s44 offen lds
  s_add_u32 m0, m0, 1024
  s_add_u32 s44, s44, 1024
  buffer_load_dwordx4 v8, s[8:11], s44 offen lds
  s_add_u32 m0, m0, 1024
  s_add_u32 s44, s44, 1024
  buffer_load_dwordx4 v8, s[8:11], s44 offen lds
  s_add_u32 m0, m0, 1024
  s_add_u32 s44, s44, 1024
  buffer_load_dwordx4 v8, s[8:11], s44 offen lds
  s_add_u32 m0, m0, 1024
  s_add_u32 s44, s44, 1024
  buffer_load_dwordx4 v8, s[8:11], s44 offen lds
  s_add_u32 m0, m0, 1024
  s_add_u32 s44, s44, 1024
  buffer_load_dwordx4 v8, s[8:11], s44 offen lds
  s_add_u32 m0, m0, 1024
  s_add_u32 s44, s44, 1024
  buffer_load_dwordx4 v8, s[8:11], s44 offen lds
  s_add_u32 m0, m0, 1024
  s_add_u32 s44, s44, 1024
  buffer_load_dwordx4 v8, s[8:11], s44 offen lds
  s_add_u32 m0, m0, 1024
  s_add_u32 s44, s44, 1024
  s_cmp_eq_u32 s33, 1
  s_cbranch_scc1 L2_pq10
  buffer_load_dwordx4 v8, s[8:11], s44 offen lds
  s_add_u32 m0, m0, 1024
  s_add_u32 s44, s44, 1024
L2_pq10:
  s_mul_i32 s32, s27, 25600
  s_mul_i32 s45, s25, 102400
  s_add_u32 s32, s32, s45
  s_mul_i32 s45, s33, 13312
  s_add_u32 s32, s32, s45
  v_mov_b32 v7, v8
  s_mov_b32 s16, s42
  s_mov_b32 s17, s43
  s_mov_b32 s18, 2621440
  s_mov_b32 s19, 0x00020000
  s_add_u32 s20, s38, 2686976
  s_addc_u32 s21, s39, 0
  s_mov_b32 s22, 2621440
  s_mov_b32 s23, 0x00020000
  s_mov_b32 s28, s38
  s_mov_b32 s29, s39
  s_mov_b32 s30, 21053440
  s_mov_b32 s31, 0x00020000
  v_lshrrev_b32 v3, 3, v2
  s_lshl_b32 s40, s24, 6
  v_add_u32 v3, s40, v3
  s_movk_i32 s41, 1280
  v_mul_lo_u32 v194, v3, s41
  v_and_b32 v4, 7, v2
  v_mad_u32_u24 v194, v4, 20, v194
  s_mul_i32 s40, s25, 160
  v_add_u32 v194, s40, v194
  buffer_load_dwordx4 v[248:251], v194, s[16:19], 0 offen
  buffer_load_dword v252, v194, s[16:19], 0 offen offset:16
  v_and_b32 v3, 15, v0
  v_lshrrev_b32 v4, 4, v0
  v_cmp_eq_u32 s[46:47], 0, v4
  v_lshrrev_b32 v5, 2, v3
  v_cmp_eq_u32 s[48:49], 0, v5
  v_cmp_eq_u32 s[56:57], 0, v4
  v_cmp_eq_u32 s[50:51], 1, v5
  v_cmp_eq_u32 s[58:59], 1, v4
  v_cmp_eq_u32 s[52:53], 2, v5
  v_cmp_eq_u32 s[60:61], 2, v4
  v_cmp_eq_u32 s[54:55], 3, v5
  v_cmp_eq_u32 s[62:63], 3, v4
  v_mul_u32_u24 v8, 80, v3
  v_add_u32 v8, s35, v8
  v_lshl_add_u32 v9, v4, 4, v8
  v_and_b32 v10, 3, v3
  v_mul_u32_u24 v10, 80, v10
  v_add_u32 v10, s35, v10
  v_add_u32 v10, 1280, v10
  v_lshl_add_u32 v11, v4, 4, v10
  v_mov_b32 v12, s35
  v_add_u32 v12, 1600, v12
  v_lshl_add_u32 v13, v4, 4, v12
  s_mul_i32 s40, s33, 10752
  s_add_u32 s40, s40, s34
  v_mul_u32_u24 v14, 336, v3
  v_add_u32 v14, s40, v14
  v_add_u32 v15, 32, v14
  v_lshl_add_u32 v14, v4, 3, v14

L2_PFRET:
  s_mov_b64 exec, -1
  s_waitcnt vmcnt(12)
  s_barrier
  ds_read_b128 v[128:131], v9 offset:0
  ds_read_b128 v[132:135], v8 offset:64
  ds_read_b128 v[136:139], v11 offset:0
  ds_read_b128 v[140:143], v10 offset:64
  ds_read_b128 v[144:147], v13 offset:0
  ds_read_b128 v[148:151], v12 offset:64
  ds_read_b128 v[152:155], v9 offset:1680
  ds_read_b128 v[156:159], v8 offset:1744
  ds_read_b128 v[160:163], v11 offset:1680
  ds_read_b128 v[164:167], v10 offset:1744
  ds_read_b128 v[168:171], v13 offset:1680
  ds_read_b128 v[172:175], v12 offset:1744
  s_waitcnt lgkmcnt(6)
  v_cvt_pk_bf16_f32 v32, v128, v129
  v_cvt_pk_bf16_f32 v33, v130, v131
  v_cvt_pk_bf16_f32 v34, v132, v133
  v_cvt_pk_bf16_f32 v35, v134, v135
  v_cvt_pk_bf16_f32 v36, v136, v137
  v_cvt_pk_bf16_f32 v37, v138, v139
  v_cvt_pk_bf16_f32 v38, v140, v141
  v_cvt_pk_bf16_f32 v39, v142, v143
  v_cvt_pk_bf16_f32 v40, v144, v145
  v_cvt_pk_bf16_f32 v41, v146, v147
  v_cvt_pk_bf16_f32 v42, v148, v149
  v_cvt_pk_bf16_f32 v43, v150, v151
  v_cndmask_b32 v34, 0, v34, s[46:47]
  v_cndmask_b32 v35, 0, v35, s[46:47]
  v_cndmask_b32 v38, 0, v38, s[46:47]
  v_cndmask_b32 v39, 0, v39, s[46:47]
  v_cndmask_b32 v42, 0, v42, s[46:47]
  v_cndmask_b32 v43, 0, v43, s[46:47]
  v_cndmask_b32 v36, 0, v36, s[48:49]
  v_cndmask_b32 v37, 0, v37, s[48:49]
  v_cndmask_b32 v38, 0, v38, s[48:49]
  v_cndmask_b32 v39, 0, v39, s[48:49]
  buffer_load_dwordx4 v[196:199], v7, s[12:15], s32 offen
  s_add_u32 s32, s32, 1024
  buffer_load_dwordx4 v[200:203], v7, s[12:15], s32 offen
  s_add_u32 s32, s32, 1024
  ds_read_b128 v[128:131], v9 offset:3360
  ds_read_b128 v[132:135], v8 offset:3424
  ds_read_b128 v[136:139], v11 offset:3360
  ds_read_b128 v[140:143], v10 offset:3424
  ds_read_b128 v[144:147], v13 offset:3360
  ds_read_b128 v[148:151], v12 offset:3424
  s_waitcnt lgkmcnt(6)
  v_cvt_pk_bf16_f32 v44, v152, v153
  v_cvt_pk_bf16_f32 v45, v154, v155
  v_cvt_pk_bf16_f32 v46, v156, v157
  v_cvt_pk_bf16_f32 v47, v158, v159
  v_cvt_pk_bf16_f32 v48, v160, v161
  v_cvt_pk_bf16_f32 v49, v162, v163
  v_cvt_pk_bf16_f32 v50, v164, v165
  v_cvt_pk_bf16_f32 v51, v166, v167
  v_cvt_pk_bf16_f32 v52, v168, v169
  v_cvt_pk_bf16_f32 v53, v170, v171
  v_cvt_pk_bf16_f32 v54, v172, v173
  v_cvt_pk_bf16_f32 v55, v174, v175
  v_cndmask_b32 v46, 0, v46, s[46:47]
  v_cndmask_b32 v47, 0, v47, s[46:47]
  v_cndmask_b32 v50, 0, v50, s[46:47]
  v_cndmask_b32 v51, 0, v51, s[46:47]
  v_cndmask_b32 v54, 0, v54, s[46:47]
  v_cndmask_b32 v55, 0, v55, s[46:47]
  v_cndmask_b32 v48, 0, v48, s[50:51]
  v_cndmask_b32 v49, 0, v49, s[50:51]
  v_cndmask_b32 v50, 0, v50, s[50:51]
  v_cndmask_b32 v51, 0, v51, s[50:51]
  buffer_load_dwordx4 v[204:207], v7, s[12:15], s32 offen
  s_add_u32 s32, s32, 1024
  buffer_load_dwordx4 v[208:211], v7, s[12:15], s32 offen
  s_add_u32 s32, s32, 1024
  ds_read_b128 v[152:155], v9 offset:5040
  ds_read_b128 v[156:159], v8 offset:5104
  ds_read_b128 v[160:163], v11 offset:5040
  ds_read_b128 v[164:167], v10 offset:5104
  ds_read_b128 v[168:171], v13 offset:5040
  ds_read_b128 v[172:175], v12 offset:5104
  s_waitcnt lgkmcnt(6)
  v_cvt_pk_bf16_f32 v56, v128, v129
  v_cvt_pk_bf16_f32 v57, v130, v131
  v_cvt_pk_bf16_f32 v58, v132, v133
  v_cvt_pk_bf16_f32 v59, v134, v135
  v_cvt_pk_bf16_f32 v60, v136, v137
  v_cvt_pk_bf16_f32 v61, v138, v139
  v_cvt_pk_bf16_f32 v62, v140, v141
  v_cvt_pk_bf16_f32 v63, v142, v143
  v_cvt_pk_bf16_f32 v64, v144, v145
  v_cvt_pk_bf16_f32 v65, v146, v147
  v_cvt_pk_bf16_f32 v66, v148, v149
  v_cvt_pk_bf16_f32 v67, v150, v151
  v_cndmask_b32 v58, 0, v58, s[46:47]
  v_cndmask_b32 v59, 0, v59, s[46:47]
  v_cndmask_b32 v62, 0, v62, s[46:47]
  v_cndmask_b32 v63, 0, v63, s[46:47]
  v_cndmask_b32 v66, 0, v66, s[46:47]
  v_cndmask_b32 v67, 0, v67, s[46:47]
  v_cndmask_b32 v60, 0, v60, s[52:53]
  v_cndmask_b32 v61, 0, v61, s[52:53]
  v_cndmask_b32 v62, 0, v62, s[52:53]
  v_cndmask_b32 v63, 0, v63, s[52:53]
  buffer_load_dwordx4 v[212:215], v7, s[12:15], s32 offen
  s_add_u32 s32, s32, 1024
  buffer_load_dwordx4 v[216:219], v7, s[12:15], s32 offen
  s_add_u32 s32, s32, 1024
  ds_read_b128 v[128:131], v9 offset:6720
  ds_read_b128 v[132:135], v8 offset:6784
  ds_read_b128 v[136:139], v11 offset:6720
  ds_read_b128 v[140:143], v10 offset:6784
  ds_read_b128 v[144:147], v13 offset:6720
  ds_read_b128 v[148:151], v12 offset:6784
  s_waitcnt lgkmcnt(6)
  v_cvt_pk_bf16_f32 v68, v152, v153
  v_cvt_pk_bf16_f32 v69, v154, v155
  v_cvt_pk_bf16_f32 v70, v156, v157
  v_cvt_pk_bf16_f32 v71, v158, v159
  v_cvt_pk_bf16_f32 v72, v160, v161
  v_cvt_pk_bf16_f32 v73, v162, v163
  v_cvt_pk_bf16_f32 v74, v164, v165
  v_cvt_pk_bf16_f32 v75, v166, v167
  v_cvt_pk_bf16_f32 v76, v168, v169
  v_cvt_pk_bf16_f32 v77, v170, v171
  v_cvt_pk_bf16_f32 v78, v172, v173
  v_cvt_pk_bf16_f32 v79, v174, v175
  v_cndmask_b32 v70, 0, v70, s[46:47]
  v_cndmask_b32 v71, 0, v71, s[46:47]
  v_cndmask_b32 v74, 0, v74, s[46:47]
  v_cndmask_b32 v75, 0, v75, s[46:47]
  v_cndmask_b32 v78, 0, v78, s[46:47]
  v_cndmask_b32 v79, 0, v79, s[46:47]
  v_cndmask_b32 v72, 0, v72, s[54:55]
  v_cndmask_b32 v73, 0, v73, s[54:55]
  v_cndmask_b32 v74, 0, v74, s[54:55]
  v_cndmask_b32 v75, 0, v75, s[54:55]
  buffer_load_dwordx4 v[220:223], v7, s[12:15], s32 offen
  s_add_u32 s32, s32, 1024
  buffer_load_dwordx4 v[224:227], v7, s[12:15], s32 offen
  s_add_u32 s32, s32, 1024
  ds_read_b128 v[152:155], v9 offset:8400
  ds_read_b128 v[156:159], v8 offset:8464
  ds_read_b128 v[160:163], v11 offset:8400
  ds_read_b128 v[164:167], v10 offset:8464
  ds_read_b128 v[168:171], v13 offset:8400
  ds_read_b128 v[172:175], v12 offset:8464
  s_waitcnt lgkmcnt(6)
  v_cvt_pk_bf16_f32 v80, v128, v129
  v_cvt_pk_bf16_f32 v81, v130, v131
  v_cvt_pk_bf16_f32 v82, v132, v133
  v_cvt_pk_bf16_f32 v83, v134, v135
  v_cvt_pk_bf16_f32 v84, v136, v137
  v_cvt_pk_bf16_f32 v85, v138, v139
  v_cvt_pk_bf16_f32 v86, v140, v141
  v_cvt_pk_bf16_f32 v87, v142, v143
  v_cvt_pk_bf16_f32 v88, v144, v145
  v_cvt_pk_bf16_f32 v89, v146, v147
  v_cvt_pk_bf16_f32 v90, v148, v149
  v_cvt_pk_bf16_f32 v91, v150, v151
  v_cndmask_b32 v82, 0, v82, s[46:47]
  v_cndmask_b32 v83, 0, v83, s[46:47]
  v_cndmask_b32 v86, 0, v86, s[46:47]
  v_cndmask_b32 v87, 0, v87, s[46:47]
  v_cndmask_b32 v90, 0, v90, s[46:47]
  v_cndmask_b32 v91, 0, v91, s[46:47]
  v_cndmask_b32 v84, 0, v84, s[48:49]
  v_cndmask_b32 v85, 0, v85, s[48:49]
  v_cndmask_b32 v86, 0, v86, s[48:49]
  v_cndmask_b32 v87, 0, v87, s[48:49]
  buffer_load_dwordx4 v[228:231], v7, s[12:15], s32 offen
  s_add_u32 s32, s32, 1024
  buffer_load_dwordx4 v[232:235], v7, s[12:15], s32 offen
  s_add_u32 s32, s32, 1024
  ds_read_b128 v[128:131], v9 offset:10080
  ds_read_b128 v[132:135], v8 offset:10144
  ds_read_b128 v[136:139], v11 offset:10080
  ds_read_b128 v[140:143], v10 offset:10144
  ds_read_b128 v[144:147], v13 offset:10080
  ds_read_b128 v[148:151], v12 offset:10144
  s_waitcnt lgkmcnt(6)
  v_cvt_pk_bf16_f32 v92, v152, v153
  v_cvt_pk_bf16_f32 v93, v154, v155
  v_cvt_pk_bf16_f32 v94, v156, v157
  v_cvt_pk_bf16_f32 v95, v158, v159
  v_cvt_pk_bf16_f32 v96, v160, v161
  v_cvt_pk_bf16_f32 v97, v162, v163
  v_cvt_pk_bf16_f32 v98, v164, v165
  v_cvt_pk_bf16_f32 v99, v166, v167
  v_cvt_pk_bf16_f32 v100, v168, v169
  v_cvt_pk_bf16_f32 v101, v170, v171
  v_cvt_pk_bf16_f32 v102, v172, v173
  v_cvt_pk_bf16_f32 v103, v174, v175
  v_cndmask_b32 v94, 0, v94, s[46:47]
  v_cndmask_b32 v95, 0, v95, s[46:47]
  v_cndmask_b32 v98, 0, v98, s[46:47]
  v_cndmask_b32 v99, 0, v99, s[46:47]
  v_cndmask_b32 v102, 0, v102, s[46:47]
  v_cndmask_b32 v103, 0, v103, s[46:47]
  v_cndmask_b32 v96, 0, v96, s[50:51]
  v_cndmask_b32 v97, 0, v97, s[50:51]
  v_cndmask_b32 v98, 0, v98, s[50:51]
  v_cndmask_b32 v99, 0, v99, s[50:51]
  buffer_load_dwordx4 v[236:239], v7, s[12:15], s32 offen
  s_add_u32 s32, s32, 1024
  buffer_load_dwordx4 v[240:243], v7, s[12:15], s32 offen
  s_add_u32 s32, s32, 1024
  ds_read_b128 v[152:155], v9 offset:11760
  ds_read_b128 v[156:159], v8 offset:11824
  ds_read_b128 v[160:163], v11 offset:11760
  ds_read_b128 v[164:167], v10 offset:11824
  ds_read_b128 v[168:171], v13 offset:11760
  ds_read_b128 v[172:175], v12 offset:11824
  s_waitcnt lgkmcnt(6)
  v_cvt_pk_bf16_f32 v104, v128, v129
  v_cvt_pk_bf16_f32 v105, v130, v131
  v_cvt_pk_bf16_f32 v106, v132, v133
  v_cvt_pk_bf16_f32 v107, v134, v135
  v_cvt_pk_bf16_f32 v108, v136, v137
  v_cvt_pk_bf16_f32 v109, v138, v139
  v_cvt_pk_bf16_f32 v110, v140, v141
  v_cvt_pk_bf16_f32 v111, v142, v143
  v_cvt_pk_bf16_f32 v112, v144, v145
  v_cvt_pk_bf16_f32 v113, v146, v147
  v_cvt_pk_bf16_f32 v114, v148, v149
  v_cvt_pk_bf16_f32 v115, v150, v151
  v_cndmask_b32 v106, 0, v106, s[46:47]
  v_cndmask_b32 v107, 0, v107, s[46:47]
  v_cndmask_b32 v110, 0, v110, s[46:47]
  v_cndmask_b32 v111, 0, v111, s[46:47]
  v_cndmask_b32 v114, 0, v114, s[46:47]
  v_cndmask_b32 v115, 0, v115, s[46:47]
  v_cndmask_b32 v108, 0, v108, s[52:53]
  v_cndmask_b32 v109, 0, v109, s[52:53]
  v_cndmask_b32 v110, 0, v110, s[52:53]
  v_cndmask_b32 v111, 0, v111, s[52:53]
  buffer_load_dwordx4 v[244:247], v7, s[12:15], s32 offen
  s_add_u32 s32, s32, 1024
  s_waitcnt lgkmcnt(0)
  v_cvt_pk_bf16_f32 v116, v152, v153
  v_cvt_pk_bf16_f32 v117, v154, v155
  v_cvt_pk_bf16_f32 v118, v156, v157
  v_cvt_pk_bf16_f32 v119, v158, v159
  v_cvt_pk_bf16_f32 v120, v160, v161
  v_cvt_pk_bf16_f32 v121, v162, v163
  v_cvt_pk_bf16_f32 v122, v164, v165
  v_cvt_pk_bf16_f32 v123, v166, v167
  v_cvt_pk_bf16_f32 v124, v168, v169
  v_cvt_pk_bf16_f32 v125, v170, v171
  v_cvt_pk_bf16_f32 v126, v172, v173
  v_cvt_pk_bf16_f32 v127, v174, v175
  v_cndmask_b32 v118, 0, v118, s[46:47]
  v_cndmask_b32 v119, 0, v119, s[46:47]
  v_cndmask_b32 v122, 0, v122, s[46:47]
  v_cndmask_b32 v123, 0, v123, s[46:47]
  v_cndmask_b32 v126, 0, v126, s[46:47]
  v_cndmask_b32 v127, 0, v127, s[46:47]
  v_cndmask_b32 v120, 0, v120, s[54:55]
  v_cndmask_b32 v121, 0, v121, s[54:55]
  v_cndmask_b32 v122, 0, v122, s[54:55]
  v_cndmask_b32 v123, 0, v123, s[54:55]
  s_waitcnt vmcnt(15)
  s_barrier
  s_mov_b32 s45, 0x358637bd
  ds_read_b64 v[168:169], v14 offset:0
  ds_read_b64 v[170:171], v15 offset:0
  ds_read_b64 v[172:173], v14 offset:5376
  ds_read_b64 v[174:175], v15 offset:5376
  ds_read_b64 v[16:17], v14 offset:40
  ds_read_b64 v[18:19], v15 offset:40
  ds_read_b64 v[20:21], v14 offset:5416
  ds_read_b64 v[22:23], v15 offset:5416
  s_waitcnt lgkmcnt(4)
  v_mfma_f32_16x16x32_bf16 v[24:27], v[40:43], v[168:171], 0
  v_mfma_f32_16x16x32_bf16 v[28:31], v[40:43], v[172:175], 0
  v_mfma_f32_16x16x32_bf16 v[176:179], v[32:35], v[168:171], 0
  v_mfma_f32_16x16x32_bf16 v[180:183], v[32:35], v[172:175], 0
  v_mfma_f32_16x16x32_bf16 v[184:187], v[36:39], v[168:171], 0
  v_mfma_f32_16x16x32_bf16 v[188:191], v[36:39], v[172:175], 0
  s_nop 4
  v_add_f32 v24, s45, v24
  v_rcp_f32 v24, v24
  v_add_f32 v28, s45, v28
  v_rcp_f32 v28, v28
  s_nop 1
  v_mul_f32 v176, v176, v24
  v_mul_f32 v177, v177, v24
  v_mul_f32 v178, v178, v24
  v_mul_f32 v179, v179, v24
  v_cvt_pk_bf16_f32 v128, v176, v177
  v_cvt_pk_bf16_f32 v129, v178, v179
  v_cndmask_b32 v192, v192, v24, s[56:57]
  v_mul_f32 v180, v180, v28
  v_mul_f32 v181, v181, v28
  v_mul_f32 v182, v182, v28
  v_mul_f32 v183, v183, v28
  v_cvt_pk_bf16_f32 v148, v180, v181
  v_cvt_pk_bf16_f32 v149, v182, v183
  v_cndmask_b32 v193, v193, v28, s[56:57]
  ds_read_b64 v[168:169], v14 offset:80
  ds_read_b64 v[170:171], v15 offset:80
  ds_read_b64 v[172:173], v14 offset:5456
  ds_read_b64 v[174:175], v15 offset:5456
  s_waitcnt lgkmcnt(4)
  v_mfma_f32_16x16x32_bf16 v[24:27], v[52:55], v[16:19], 0
  v_mfma_f32_16x16x32_bf16 v[28:31], v[52:55], v[20:23], 0
  v_mfma_f32_16x16x32_bf16 v[176:179], v[44:47], v[16:19], 0
  v_mfma_f32_16x16x32_bf16 v[180:183], v[44:47], v[20:23], 0
  v_mfma_f32_16x16x32_bf16 v[184:187], v[48:51], v[16:19], v[184:187]
  v_mfma_f32_16x16x32_bf16 v[188:191], v[48:51], v[20:23], v[188:191]
  s_nop 4
  v_add_f32 v24, s45, v24
  v_rcp_f32 v24, v24
  v_add_f32 v28, s45, v28
  v_rcp_f32 v28, v28
  s_nop 1
  v_mul_f32 v176, v176, v24
  v_mul_f32 v177, v177, v24
  v_mul_f32 v178, v178, v24
  v_mul_f32 v179, v179, v24
  v_cvt_pk_bf16_f32 v130, v176, v177
  v_cvt_pk_bf16_f32 v131, v178, v179
  v_cndmask_b32 v192, v192, v24, s[58:59]
  v_mul_f32 v180, v180, v28
  v_mul_f32 v181, v181, v28
  v_mul_f32 v182, v182, v28
  v_mul_f32 v183, v183, v28
  v_cvt_pk_bf16_f32 v150, v180, v181
  v_cvt_pk_bf16_f32 v151, v182, v183
  v_cndmask_b32 v193, v193, v28, s[58:59]
  ds_read_b64 v[16:17], v14 offset:120
  ds_read_b64 v[18:19], v15 offset:120
  ds_read_b64 v[20:21], v14 offset:5496
  ds_read_b64 v[22:23], v15 offset:5496
  s_waitcnt lgkmcnt(4)
  v_mfma_f32_16x16x32_bf16 v[24:27], v[64:67], v[168:171], 0
  v_mfma_f32_16x16x32_bf16 v[28:31], v[64:67], v[172:175], 0
  v_mfma_f32_16x16x32_bf16 v[176:179], v[56:59], v[168:171], 0
  v_mfma_f32_16x16x32_bf16 v[180:183], v[56:59], v[172:175], 0
  v_mfma_f32_16x16x32_bf16 v[184:187], v[60:63], v[168:171], v[184:187]
  v_mfma_f32_16x16x32_bf16 v[188:191], v[60:63], v[172:175], v[188:191]
  s_nop 4
  v_add_f32 v24, s45, v24
  v_rcp_f32 v24, v24
  v_add_f32 v28, s45, v28
  v_rcp_f32 v28, v28
  s_nop 1
  v_mul_f32 v176, v176, v24
  v_mul_f32 v177, v177, v24
  v_mul_f32 v178, v178, v24
  v_mul_f32 v179, v179, v24
  v_cvt_pk_bf16_f32 v132, v176, v177
  v_cvt_pk_bf16_f32 v133, v178, v179
  v_cndmask_b32 v192, v192, v24, s[60:61]
  v_mul_f32 v180, v180, v28
  v_mul_f32 v181, v181, v28
  v_mul_f32 v182, v182, v28
  v_mul_f32 v183, v183, v28
  v_cvt_pk_bf16_f32 v152, v180, v181
  v_cvt_pk_bf16_f32 v153, v182, v183
  v_cndmask_b32 v193, v193, v28, s[60:61]
  ds_read_b64 v[168:169], v14 offset:160
  ds_read_b64 v[170:171], v15 offset:160
  ds_read_b64 v[172:173], v14 offset:5536
  ds_read_b64 v[174:175], v15 offset:5536
  s_waitcnt lgkmcnt(4)
  v_mfma_f32_16x16x32_bf16 v[24:27], v[76:79], v[16:19], 0
  v_mfma_f32_16x16x32_bf16 v[28:31], v[76:79], v[20:23], 0
  v_mfma_f32_16x16x32_bf16 v[176:179], v[68:71], v[16:19], 0
  v_mfma_f32_16x16x32_bf16 v[180:183], v[68:71], v[20:23], 0
  v_mfma_f32_16x16x32_bf16 v[184:187], v[72:75], v[16:19], v[184:187]
  v_mfma_f32_16x16x32_bf16 v[188:191], v[72:75], v[20:23], v[188:191]
  s_nop 4
  v_add_f32 v24, s45, v24
  v_rcp_f32 v24, v24
  v_add_f32 v28, s45, v28
  v_rcp_f32 v28, v28
  s_nop 1
  v_mul_f32 v176, v176, v24
  v_mul_f32 v177, v177, v24
  v_mul_f32 v178, v178, v24
  v_mul_f32 v179, v179, v24
  v_cvt_pk_bf16_f32 v134, v176, v177
  v_cvt_pk_bf16_f32 v135, v178, v179
  v_cndmask_b32 v192, v192, v24, s[62:63]
  v_mul_f32 v180, v180, v28
  v_mul_f32 v181, v181, v28
  v_mul_f32 v182, v182, v28
  v_mul_f32 v183, v183, v28
  v_cvt_pk_bf16_f32 v154, v180, v181
  v_cvt_pk_bf16_f32 v155, v182, v183
  v_cndmask_b32 v193, v193, v28, s[62:63]
  s_nop 4
  v_mul_f32 v24, v184, v192
  v_mul_f32 v25, v185, v192
  v_mul_f32 v26, v186, v192
  v_mul_f32 v27, v187, v192
  v_cvt_pk_bf16_f32 v144, v24, v25
  v_cvt_pk_bf16_f32 v145, v26, v27
  v_mul_f32 v28, v188, v193
  v_mul_f32 v29, v189, v193
  v_mul_f32 v30, v190, v193
  v_mul_f32 v31, v191, v193
  v_cvt_pk_bf16_f32 v164, v28, v29
  v_cvt_pk_bf16_f32 v165, v30, v31
  ds_read_b64 v[16:17], v14 offset:200
  ds_read_b64 v[18:19], v15 offset:200
  ds_read_b64 v[20:21], v14 offset:5576
  ds_read_b64 v[22:23], v15 offset:5576
  s_waitcnt lgkmcnt(4)
  v_mfma_f32_16x16x32_bf16 v[24:27], v[88:91], v[168:171], 0
  v_mfma_f32_16x16x32_bf16 v[28:31], v[88:91], v[172:175], 0
  v_mfma_f32_16x16x32_bf16 v[176:179], v[80:83], v[168:171], 0
  v_mfma_f32_16x16x32_bf16 v[180:183], v[80:83], v[172:175], 0
  v_mfma_f32_16x16x32_bf16 v[184:187], v[84:87], v[168:171], 0
  v_mfma_f32_16x16x32_bf16 v[188:191], v[84:87], v[172:175], 0
  s_nop 4
  v_add_f32 v24, s45, v24
  v_rcp_f32 v24, v24
  v_add_f32 v28, s45, v28
  v_rcp_f32 v28, v28
  s_nop 1
  v_mul_f32 v176, v176, v24
  v_mul_f32 v177, v177, v24
  v_mul_f32 v178, v178, v24
  v_mul_f32 v179, v179, v24
  v_cvt_pk_bf16_f32 v136, v176, v177
  v_cvt_pk_bf16_f32 v137, v178, v179
  v_cndmask_b32 v192, v192, v24, s[56:57]
  v_mul_f32 v180, v180, v28
  v_mul_f32 v181, v181, v28
  v_mul_f32 v182, v182, v28
  v_mul_f32 v183, v183, v28
  v_cvt_pk_bf16_f32 v156, v180, v181
  v_cvt_pk_bf16_f32 v157, v182, v183
  v_cndmask_b32 v193, v193, v28, s[56:57]
  ds_read_b64 v[168:169], v14 offset:240
  ds_read_b64 v[170:171], v15 offset:240
  ds_read_b64 v[172:173], v14 offset:5616
  ds_read_b64 v[174:175], v15 offset:5616
  s_waitcnt lgkmcnt(4)
  v_mfma_f32_16x16x32_bf16 v[24:27], v[100:103], v[16:19], 0
  v_mfma_f32_16x16x32_bf16 v[28:31], v[100:103], v[20:23], 0
  v_mfma_f32_16x16x32_bf16 v[176:179], v[92:95], v[16:19], 0
  v_mfma_f32_16x16x32_bf16 v[180:183], v[92:95], v[20:23], 0
  v_mfma_f32_16x16x32_bf16 v[184:187], v[96:99], v[16:19], v[184:187]
  v_mfma_f32_16x16x32_bf16 v[188:191], v[96:99], v[20:23], v[188:191]
  s_nop 4
  v_add_f32 v24, s45, v24
  v_rcp_f32 v24, v24
  v_add_f32 v28, s45, v28
  v_rcp_f32 v28, v28
  s_nop 1
  v_mul_f32 v176, v176, v24
  v_mul_f32 v177, v177, v24
  v_mul_f32 v178, v178, v24
  v_mul_f32 v179, v179, v24
  v_cvt_pk_bf16_f32 v138, v176, v177
  v_cvt_pk_bf16_f32 v139, v178, v179
  v_cndmask_b32 v192, v192, v24, s[58:59]
  v_mul_f32 v180, v180, v28
  v_mul_f32 v181, v181, v28
  v_mul_f32 v182, v182, v28
  v_mul_f32 v183, v183, v28
  v_cvt_pk_bf16_f32 v158, v180, v181
  v_cvt_pk_bf16_f32 v159, v182, v183
  v_cndmask_b32 v193, v193, v28, s[58:59]
  ds_read_b64 v[16:17], v14 offset:280
  ds_read_b64 v[18:19], v15 offset:280
  ds_read_b64 v[20:21], v14 offset:5656
  ds_read_b64 v[22:23], v15 offset:5656
  s_waitcnt lgkmcnt(4)
  v_mfma_f32_16x16x32_bf16 v[24:27], v[112:115], v[168:171], 0
  v_mfma_f32_16x16x32_bf16 v[28:31], v[112:115], v[172:175], 0
  v_mfma_f32_16x16x32_bf16 v[176:179], v[104:107], v[168:171], 0
  v_mfma_f32_16x16x32_bf16 v[180:183], v[104:107], v[172:175], 0
  v_mfma_f32_16x16x32_bf16 v[184:187], v[108:111], v[168:171], v[184:187]
  v_mfma_f32_16x16x32_bf16 v[188:191], v[108:111], v[172:175], v[188:191]
  s_nop 4
  v_add_f32 v24, s45, v24
  v_rcp_f32 v24, v24
  v_add_f32 v28, s45, v28
  v_rcp_f32 v28, v28
  s_nop 1
  v_mul_f32 v176, v176, v24
  v_mul_f32 v177, v177, v24
  v_mul_f32 v178, v178, v24
  v_mul_f32 v179, v179, v24
  v_cvt_pk_bf16_f32 v140, v176, v177
  v_cvt_pk_bf16_f32 v141, v178, v179
  v_cndmask_b32 v192, v192, v24, s[60:61]
  v_mul_f32 v180, v180, v28
  v_mul_f32 v181, v181, v28
  v_mul_f32 v182, v182, v28
  v_mul_f32 v183, v183, v28
  v_cvt_pk_bf16_f32 v160, v180, v181
  v_cvt_pk_bf16_f32 v161, v182, v183
  v_cndmask_b32 v193, v193, v28, s[60:61]
  s_waitcnt lgkmcnt(0)
  v_mfma_f32_16x16x32_bf16 v[24:27], v[124:127], v[16:19], 0
  v_mfma_f32_16x16x32_bf16 v[28:31], v[124:127], v[20:23], 0
  v_mfma_f32_16x16x32_bf16 v[176:179], v[116:119], v[16:19], 0
  v_mfma_f32_16x16x32_bf16 v[180:183], v[116:119], v[20:23], 0
  v_mfma_f32_16x16x32_bf16 v[184:187], v[120:123], v[16:19], v[184:187]
  v_mfma_f32_16x16x32_bf16 v[188:191], v[120:123], v[20:23], v[188:191]
  s_nop 4
  v_add_f32 v24, s45, v24
  v_rcp_f32 v24, v24
  v_add_f32 v28, s45, v28
  v_rcp_f32 v28, v28
  s_nop 1
  v_mul_f32 v176, v176, v24
  v_mul_f32 v177, v177, v24
  v_mul_f32 v178, v178, v24
  v_mul_f32 v179, v179, v24
  v_cvt_pk_bf16_f32 v142, v176, v177
  v_cvt_pk_bf16_f32 v143, v178, v179
  v_cndmask_b32 v192, v192, v24, s[62:63]
  v_mul_f32 v180, v180, v28
  v_mul_f32 v181, v181, v28
  v_mul_f32 v182, v182, v28
  v_mul_f32 v183, v183, v28
  v_cvt_pk_bf16_f32 v162, v180, v181
  v_cvt_pk_bf16_f32 v163, v182, v183
  v_cndmask_b32 v193, v193, v28, s[62:63]
  s_nop 4
  v_mul_f32 v24, v184, v192
  v_mul_f32 v25, v185, v192
  v_mul_f32 v26, v186, v192
  v_mul_f32 v27, v187, v192
  v_cvt_pk_bf16_f32 v146, v24, v25
  v_cvt_pk_bf16_f32 v147, v26, v27
  v_mul_f32 v28, v188, v193
  v_mul_f32 v29, v189, v193
  v_mul_f32 v30, v190, v193
  v_mul_f32 v31, v191, v193
  v_cvt_pk_bf16_f32 v166, v28, v29
  v_cvt_pk_bf16_f32 v167, v30, v31
  v_lshlrev_b32 v16, 4, v0
  s_mul_i32 s40, s33, 13312
  s_add_u32 s40, s40, s34
  v_add_u32 v16, s40, v16
  v_lshl_add_u32 v8, v4, 2, v5
  v_mul_u32_u24 v8, 160, v8
  v_and_b32 v6, 3, v3
  v_lshl_add_u32 v8, v6, 3, v8
  v_add_u32 v8, s34, v8
  v_mul_u32_u24 v9, 20, v4
  v_add_u32 v9, v9, v5
  v_add_u32 v9, 16, v9
  v_mul_u32_u24 v9, 160, v9
  v_lshl_add_u32 v9, v6, 3, v9
  v_add_u32 v9, s34, v9
  s_waitcnt vmcnt(0)
  s_barrier
  ds_write_b128 v16, v[196:199] offset:0
  ds_write_b128 v16, v[200:203] offset:1024
  ds_write_b128 v16, v[204:207] offset:2048
  ds_write_b128 v16, v[208:211] offset:3072
  ds_write_b128 v16, v[212:215] offset:4096
  ds_write_b128 v16, v[216:219] offset:5120
  ds_write_b128 v16, v[220:223] offset:6144
  ds_write_b128 v16, v[224:227] offset:7168
  ds_write_b128 v16, v[228:231] offset:8192
  ds_write_b128 v16, v[232:235] offset:9216
  ds_write_b128 v16, v[236:239] offset:10240
  ds_write_b128 v16, v[240:243] offset:11264
  s_cmp_eq_u32 s33, 1
  s_cbranch_scc1 L2_w12
  ds_write_b128 v16, v[244:247] offset:12288
L2_w12:
  s_waitcnt lgkmcnt(0)
  s_barrier
  ds_read_b64_tr_b16 v[72:73], v8 offset:0
  ds_read_b64_tr_b16 v[74:75], v8 offset:3200
  ds_read_b64_tr_b16 v[76:77], v8 offset:32
  ds_read_b64_tr_b16 v[78:79], v8 offset:3232
  ds_read_b64_tr_b16 v[80:81], v8 offset:64
  ds_read_b64_tr_b16 v[82:83], v8 offset:3264
  ds_read_b64_tr_b16 v[84:85], v8 offset:96
  ds_read_b64_tr_b16 v[86:87], v8 offset:3296
  ds_read_b64_tr_b16 v[88:89], v8 offset:128
  ds_read_b64_tr_b16 v[90:91], v8 offset:3328
  s_waitcnt lgkmcnt(0)
  v_mfma_f32_16x16x32_bf16 v[32:35], v[72:75], v[128:131], 0
  ds_read_b64_tr_b16 v[92:93], v8 offset:6400
  v_mfma_f32_16x16x32_bf16 v[52:55], v[72:75], v[148:151], 0
  ds_read_b64_tr_b16 v[94:95], v8 offset:9600
  v_mfma_f32_16x16x32_bf16 v[36:39], v[76:79], v[128:131], 0
  ds_read_b64_tr_b16 v[96:97], v8 offset:6432
  v_mfma_f32_16x16x32_bf16 v[56:59], v[76:79], v[148:151], 0
  ds_read_b64_tr_b16 v[98:99], v8 offset:9632
  v_mfma_f32_16x16x32_bf16 v[40:43], v[80:83], v[128:131], 0
  ds_read_b64_tr_b16 v[100:101], v8 offset:6464
  v_mfma_f32_16x16x32_bf16 v[60:63], v[80:83], v[148:151], 0
  ds_read_b64_tr_b16 v[102:103], v8 offset:9664
  v_mfma_f32_16x16x32_bf16 v[44:47], v[84:87], v[128:131], 0
  ds_read_b64_tr_b16 v[104:105], v8 offset:6496
  v_mfma_f32_16x16x32_bf16 v[64:67], v[84:87], v[148:151], 0
  ds_read_b64_tr_b16 v[106:107], v8 offset:9696
  v_mfma_f32_16x16x32_bf16 v[48:51], v[88:91], v[128:131], 0
  ds_read_b64_tr_b16 v[108:109], v8 offset:6528
  v_mfma_f32_16x16x32_bf16 v[68:71], v[88:91], v[148:151], 0
  ds_read_b64_tr_b16 v[110:111], v8 offset:9728
  s_waitcnt lgkmcnt(0)
  v_mfma_f32_16x16x32_bf16 v[32:35], v[92:95], v[132:135], v[32:35]
  ds_read_b64_tr_b16 v[72:73], v8 offset:12800
  v_mfma_f32_16x16x32_bf16 v[52:55], v[92:95], v[152:155], v[52:55]
  ds_read_b64_tr_b16 v[74:75], v8 offset:16000
  v_mfma_f32_16x16x32_bf16 v[36:39], v[96:99], v[132:135], v[36:39]
  ds_read_b64_tr_b16 v[76:77], v8 offset:12832
  v_mfma_f32_16x16x32_bf16 v[56:59], v[96:99], v[152:155], v[56:59]
  ds_read_b64_tr_b16 v[78:79], v8 offset:16032
  v_mfma_f32_16x16x32_bf16 v[40:43], v[100:103], v[132:135], v[40:43]
  ds_read_b64_tr_b16 v[80:81], v8 offset:12864
  v_mfma_f32_16x16x32_bf16 v[60:63], v[100:103], v[152:155], v[60:63]
  ds_read_b64_tr_b16 v[82:83], v8 offset:16064
  v_mfma_f32_16x16x32_bf16 v[44:47], v[104:107], v[132:135], v[44:47]
  ds_read_b64_tr_b16 v[84:85], v8 offset:12896
  v_mfma_f32_16x16x32_bf16 v[64:67], v[104:107], v[152:155], v[64:67]
  ds_read_b64_tr_b16 v[86:87], v8 offset:16096
  v_mfma_f32_16x16x32_bf16 v[48:51], v[108:111], v[132:135], v[48:51]
  ds_read_b64_tr_b16 v[88:89], v8 offset:12928
  v_mfma_f32_16x16x32_bf16 v[68:71], v[108:111], v[152:155], v[68:71]
  ds_read_b64_tr_b16 v[90:91], v8 offset:16128
  s_waitcnt lgkmcnt(0)
  v_mfma_f32_16x16x32_bf16 v[32:35], v[72:75], v[136:139], v[32:35]
  ds_read_b64_tr_b16 v[92:93], v8 offset:19200
  v_mfma_f32_16x16x32_bf16 v[52:55], v[72:75], v[156:159], v[52:55]
  ds_read_b64_tr_b16 v[94:95], v8 offset:22400
  v_mfma_f32_16x16x32_bf16 v[36:39], v[76:79], v[136:139], v[36:39]
  ds_read_b64_tr_b16 v[96:97], v8 offset:19232
  v_mfma_f32_16x16x32_bf16 v[56:59], v[76:79], v[156:159], v[56:59]
  ds_read_b64_tr_b16 v[98:99], v8 offset:22432
  v_mfma_f32_16x16x32_bf16 v[40:43], v[80:83], v[136:139], v[40:43]
  ds_read_b64_tr_b16 v[100:101], v8 offset:19264
  v_mfma_f32_16x16x32_bf16 v[60:63], v[80:83], v[156:159], v[60:63]
  ds_read_b64_tr_b16 v[102:103], v8 offset:22464
  v_mfma_f32_16x16x32_bf16 v[44:47], v[84:87], v[136:139], v[44:47]
  ds_read_b64_tr_b16 v[104:105], v8 offset:19296
  v_mfma_f32_16x16x32_bf16 v[64:67], v[84:87], v[156:159], v[64:67]
  ds_read_b64_tr_b16 v[106:107], v8 offset:22496
  v_mfma_f32_16x16x32_bf16 v[48:51], v[88:91], v[136:139], v[48:51]
  ds_read_b64_tr_b16 v[108:109], v8 offset:19328
  v_mfma_f32_16x16x32_bf16 v[68:71], v[88:91], v[156:159], v[68:71]
  ds_read_b64_tr_b16 v[110:111], v8 offset:22528
  s_waitcnt lgkmcnt(0)
  v_mfma_f32_16x16x32_bf16 v[32:35], v[92:95], v[140:143], v[32:35]
  ds_read_b64_tr_b16 v[72:73], v9 offset:0
  v_mfma_f32_16x16x32_bf16 v[52:55], v[92:95], v[160:163], v[52:55]
  ds_read_b64_tr_b16 v[74:75], v9 offset:12800
  v_mfma_f32_16x16x32_bf16 v[36:39], v[96:99], v[140:143], v[36:39]
  ds_read_b64_tr_b16 v[76:77], v9 offset:32
  v_mfma_f32_16x16x32_bf16 v[56:59], v[96:99], v[160:163], v[56:59]
  ds_read_b64_tr_b16 v[78:79], v9 offset:12832
  v_mfma_f32_16x16x32_bf16 v[40:43], v[100:103], v[140:143], v[40:43]
  ds_read_b64_tr_b16 v[80:81], v9 offset:64
  v_mfma_f32_16x16x32_bf16 v[60:63], v[100:103], v[160:163], v[60:63]
  ds_read_b64_tr_b16 v[82:83], v9 offset:12864
  v_mfma_f32_16x16x32_bf16 v[44:47], v[104:107], v[140:143], v[44:47]
  ds_read_b64_tr_b16 v[84:85], v9 offset:96
  v_mfma_f32_16x16x32_bf16 v[64:67], v[104:107], v[160:163], v[64:67]
  ds_read_b64_tr_b16 v[86:87], v9 offset:12896
  v_mfma_f32_16x16x32_bf16 v[48:51], v[108:111], v[140:143], v[48:51]
  ds_read_b64_tr_b16 v[88:89], v9 offset:128
  v_mfma_f32_16x16x32_bf16 v[68:71], v[108:111], v[160:163], v[68:71]
  ds_read_b64_tr_b16 v[90:91], v9 offset:12928
  s_waitcnt lgkmcnt(0)
  v_mfma_f32_16x16x32_bf16 v[32:35], v[72:75], v[144:147], v[32:35]
  v_mfma_f32_16x16x32_bf16 v[52:55], v[72:75], v[164:167], v[52:55]
  v_mfma_f32_16x16x32_bf16 v[36:39], v[76:79], v[144:147], v[36:39]
  v_mfma_f32_16x16x32_bf16 v[56:59], v[76:79], v[164:167], v[56:59]
  v_mfma_f32_16x16x32_bf16 v[40:43], v[80:83], v[144:147], v[40:43]
  v_mfma_f32_16x16x32_bf16 v[60:63], v[80:83], v[164:167], v[60:63]
  v_mfma_f32_16x16x32_bf16 v[44:47], v[84:87], v[144:147], v[44:47]
  v_mfma_f32_16x16x32_bf16 v[64:67], v[84:87], v[164:167], v[64:67]
  v_mfma_f32_16x16x32_bf16 v[48:51], v[88:91], v[144:147], v[48:51]
  v_mfma_f32_16x16x32_bf16 v[68:71], v[88:91], v[164:167], v[68:71]
  s_barrier
  s_mul_i32 s40, s33, 10752
  s_add_u32 s40, s40, s34
  v_mul_u32_u24 v5, 336, v3
  v_lshl_add_u32 v5, v4, 4, v5
  v_add_u32 v5, s40, v5
  ds_write_b128 v5, v[32:35] offset:0
  ds_write_b128 v5, v[36:39] offset:64
  ds_write_b128 v5, v[40:43] offset:128
  ds_write_b128 v5, v[44:47] offset:192
  ds_write_b128 v5, v[48:51] offset:256
  ds_write_b128 v5, v[52:55] offset:5376
  ds_write_b128 v5, v[56:59] offset:5440
  ds_write_b128 v5, v[60:63] offset:5504
  ds_write_b128 v5, v[64:67] offset:5568
  ds_write_b128 v5, v[68:71] offset:5632
  s_waitcnt lgkmcnt(0)
  s_barrier
  v_lshrrev_b32 v3, 3, v2
  v_and_b32 v4, 7, v2
  v_mul_u32_u24 v6, 336, v3
  v_mad_u32_u24 v6, v4, 40, v6
  v_add_u32 v5, 81920, v6
  ds_read_b64 v[32:33], v6 offset:0
  ds_read_b64 v[34:35], v6 offset:8
  ds_read_b64 v[36:37], v6 offset:16
  ds_read_b64 v[38:39], v6 offset:24
  ds_read_b64 v[40:41], v6 offset:32
  ds_read_b64 v[42:43], v6 offset:40960
  ds_read_b64 v[44:45], v6 offset:40968
  ds_read_b64 v[46:47], v6 offset:40976
  ds_read_b64 v[48:49], v6 offset:40984
  ds_read_b64 v[50:51], v6 offset:40992
  ds_read_b64 v[52:53], v5 offset:0
  ds_read_b64 v[54:55], v5 offset:8
  ds_read_b64 v[56:57], v5 offset:16
  ds_read_b64 v[58:59], v5 offset:24
  ds_read_b64 v[60:61], v5 offset:32
  ds_read_b64 v[62:63], v5 offset:40960
  ds_read_b64 v[64:65], v5 offset:40968
  ds_read_b64 v[66:67], v5 offset:40976
  ds_read_b64 v[68:69], v5 offset:40984
  ds_read_b64 v[70:71], v5 offset:40992
  s_waitcnt lgkmcnt(0)
  v_pk_add_f32 v[32:33], v[32:33], v[42:43]
  v_pk_add_f32 v[52:53], v[52:53], v[62:63]
  v_pk_add_f32 v[34:35], v[34:35], v[44:45]
  v_pk_add_f32 v[54:55], v[54:55], v[64:65]
  v_pk_add_f32 v[36:37], v[36:37], v[46:47]
  v_pk_add_f32 v[56:57], v[56:57], v[66:67]
  v_pk_add_f32 v[38:39], v[38:39], v[48:49]
  v_pk_add_f32 v[58:59], v[58:59], v[68:69]
  v_pk_add_f32 v[40:41], v[40:41], v[50:51]
  v_pk_add_f32 v[60:61], v[60:61], v[70:71]
  v_pk_add_f32 v[32:33], v[32:33], v[52:53]
  v_pk_add_f32 v[34:35], v[34:35], v[54:55]
  v_pk_add_f32 v[36:37], v[36:37], v[56:57]
  v_pk_add_f32 v[38:39], v[38:39], v[58:59]
  v_pk_add_f32 v[40:41], v[40:41], v[60:61]
  s_waitcnt vmcnt(0)
  v_lshlrev_b32 v42, 16, v248
  v_and_b32 v43, 0xffff0000, v248
  v_cvt_pk_bf16_f32 v44, v32, v33
  v_lshlrev_b32 v32, 16, v44
  v_and_b32 v33, 0xffff0000, v44
  v_pk_add_f32 v[32:33], v[32:33], v[42:43]
  v_cvt_pk_bf16_f32 v46, v32, v33
  v_lshlrev_b32 v42, 16, v249
  v_and_b32 v43, 0xffff0000, v249
  v_cvt_pk_bf16_f32 v44, v34, v35
  v_lshlrev_b32 v34, 16, v44
  v_and_b32 v35, 0xffff0000, v44
  v_pk_add_f32 v[34:35], v[34:35], v[42:43]
  v_cvt_pk_bf16_f32 v47, v34, v35
  v_lshlrev_b32 v42, 16, v250
  v_and_b32 v43, 0xffff0000, v250
  v_cvt_pk_bf16_f32 v44, v36, v37
  v_lshlrev_b32 v36, 16, v44
  v_and_b32 v37, 0xffff0000, v44
  v_pk_add_f32 v[36:37], v[36:37], v[42:43]
  v_cvt_pk_bf16_f32 v48, v36, v37
  v_lshlrev_b32 v42, 16, v251
  v_and_b32 v43, 0xffff0000, v251
  v_cvt_pk_bf16_f32 v44, v38, v39
  v_lshlrev_b32 v38, 16, v44
  v_and_b32 v39, 0xffff0000, v44
  v_pk_add_f32 v[38:39], v[38:39], v[42:43]
  v_cvt_pk_bf16_f32 v49, v38, v39
  v_lshlrev_b32 v42, 16, v252
  v_and_b32 v43, 0xffff0000, v252
  v_cvt_pk_bf16_f32 v44, v40, v41
  v_lshlrev_b32 v40, 16, v44
  v_and_b32 v41, 0xffff0000, v44
  v_pk_add_f32 v[40:41], v[40:41], v[42:43]
  v_cvt_pk_bf16_f32 v50, v40, v41
  buffer_store_dwordx4 v[46:49], v194, s[20:23], 0 offen
  buffer_store_dword v50, v194, s[20:23], 0 offen offset:16
  v_lshlrev_b32 v42, 16, v46
  v_and_b32 v43, 0xffff0000, v46
  v_mov_b32 v52, v42
  v_mov_b32 v53, v43
  v_pk_mul_f32 v[54:55], v[42:43], v[42:43]
  v_lshlrev_b32 v42, 16, v47
  v_and_b32 v43, 0xffff0000, v47
  v_pk_add_f32 v[52:53], v[52:53], v[42:43]
  v_pk_fma_f32 v[54:55], v[42:43], v[42:43], v[54:55]
  v_lshlrev_b32 v42, 16, v48
  v_and_b32 v43, 0xffff0000, v48
  v_pk_add_f32 v[52:53], v[52:53], v[42:43]
  v_pk_fma_f32 v[54:55], v[42:43], v[42:43], v[54:55]
  v_lshlrev_b32 v42, 16, v49
  v_and_b32 v43, 0xffff0000, v49
  v_pk_add_f32 v[52:53], v[52:53], v[42:43]
  v_pk_fma_f32 v[54:55], v[42:43], v[42:43], v[54:55]
  v_lshlrev_b32 v42, 16, v50
  v_and_b32 v43, 0xffff0000, v50
  v_pk_add_f32 v[52:53], v[52:53], v[42:43]
  v_pk_fma_f32 v[54:55], v[42:43], v[42:43], v[54:55]
  v_add_f32 v52, v52, v53
  v_add_f32 v53, v54, v55
  s_nop 1
  v_add_f32_dpp v52, v52, v52 quad_perm:[1,0,3,2] row_mask:0xf bank_mask:0xf
  v_add_f32_dpp v53, v53, v53 quad_perm:[1,0,3,2] row_mask:0xf bank_mask:0xf
  s_nop 1
  v_add_f32_dpp v52, v52, v52 quad_perm:[2,3,0,1] row_mask:0xf bank_mask:0xf
  v_add_f32_dpp v53, v53, v53 quad_perm:[2,3,0,1] row_mask:0xf bank_mask:0xf
  s_nop 1
  v_add_f32_dpp v52, v52, v52 row_half_mirror row_mask:0xf bank_mask:0xf
  v_add_f32_dpp v53, v53, v53 row_half_mirror row_mask:0xf bank_mask:0xf
  s_lshl_b32 s40, s24, 12
  s_lshl_b32 s41, s25, 3
  s_add_u32 s40, s40, s41
  s_add_u32 s40, s40, 12386304
  v_lshlrev_b32 v3, 6, v3
  v_cmp_eq_u32 vcc, 0, v4
  s_and_saveexec_b64 s[50:51], vcc
  buffer_store_dwordx2 v[52:53], v3, s[28:31], s40 offen
  s_mov_b64 exec, -1
L2_nost:
L2_done:
  s_endpgm
.globl k3_ffn1_kernel
.p2align 8
.type k3_ffn1_kernel,@function
k3_ffn1_kernel:
  s_cmp_ge_u32 s2, 256
  s_cbranch_scc1 L3_done
  s_load_dwordx2 s[4:5], s[0:1], 64
  s_load_dwordx2 s[6:7], s[0:1], 32
  s_load_dwordx4 s[36:39], s[0:1], 56
  s_and_b32 s40, s2, 7
  s_lshr_b32 s41, s2, 3
  s_lshr_b32 s24, s40, 1
  s_lshl_b32 s24, s24, 2
  s_and_b32 s42, s41, 3
  s_add_u32 s24, s24, s42
  s_and_b32 s25, s40, 1
  s_lshl_b32 s25, s25, 3
  s_lshr_b32 s42, s41, 2
  s_add_u32 s25, s25, s42
  v_lshrrev_b32 v1, 6, v0
  v_and_b32 v0, 63, v0
  v_readfirstlane_b32 s26, v1
  s_waitcnt lgkmcnt(0)
  s_add_u32 s8, s4, 2686976
  s_addc_u32 s9, s5, 0
  s_mov_b32 s10, 2621440
  s_mov_b32 s11, 0x00020000
  s_add_u32 s12, s4, 12517376
  s_addc_u32 s13, s5, 0
  s_mov_b32 s14, 2621440
  s_mov_b32 s15, 0x00020000
  s_mov_b32 s16, s38
  s_mov_b32 s17, s39
  s_mov_b32 s18, 21053440
  s_mov_b32 s19, 0x00020000
  s_mov_b32 s20, s36
  s_mov_b32 s21, s37
  s_mov_b32 s22, 256
  s_mov_b32 s23, 0x00020000
  s_cmp_ge_u32 s26, 4
  s_cbranch_scc1 L3_loader
  s_lshr_b32 s27, s26, 1
  s_and_b32 s28, s26, 1
  v_and_b32 v8, 15, v0
  v_lshrrev_b32 v9, 4, v0
  v_and_b32 v10, 7, v8
  v_xor_b32 v10, v10, v9
  v_lshlrev_b32 v10, 4, v10
  v_lshl_add_u32 v10, v8, 7, v10
  s_lshl_b32 s40, s27, 13
  v_add_u32 v2, s40, v10
  v_xor_b32 v3, 64, v2
  v_lshrrev_b32 v10, 2, v8
  v_and_b32 v11, 1, v9
  v_lshl_add_u32 v11, v11, 2, v10
  v_lshl_add_u32 v10, v9, 3, v10
  v_lshlrev_b32 v10, 8, v10
  v_add_u32 v10, 16384, v10
  v_and_b32 v12, 3, v8
  s_lshl_b32 s40, s28, 4
  s_add_u32 s40, s40, 0
  v_add_u32 v144, s40, v12
  v_lshrrev_b32 v145, 2, v144
  v_xor_b32 v145, v145, v11
  v_lshl_add_u32 v145, v145, 5, v10
  v_and_b32 v144, 3, v144
  v_lshl_add_u32 v4, v144, 3, v145
  s_lshl_b32 s40, s28, 4
  s_add_u32 s40, s40, 4
  v_add_u32 v144, s40, v12
  v_lshrrev_b32 v145, 2, v144
  v_xor_b32 v145, v145, v11
  v_lshl_add_u32 v145, v145, 5, v10
  v_and_b32 v144, 3, v144
  v_lshl_add_u32 v5, v144, 3, v145
  s_lshl_b32 s40, s28, 4
  s_add_u32 s40, s40, 8
  v_add_u32 v144, s40, v12
  v_lshrrev_b32 v145, 2, v144
  v_xor_b32 v145, v145, v11
  v_lshl_add_u32 v145, v145, 5, v10
  v_and_b32 v144, 3, v144
  v_lshl_add_u32 v6, v144, 3, v145
  s_lshl_b32 s40, s28, 4
  s_add_u32 s40, s40, 12
  v_add_u32 v144, s40, v12
  v_lshrrev_b32 v145, 2, v144
  v_xor_b32 v145, v145, v11
  v_lshl_add_u32 v145, v145, 5, v10
  v_and_b32 v144, 3, v144
  v_lshl_add_u32 v7, v144, 3, v145
  v_mov_b32 v80, 0
  v_mov_b32 v81, 0
  v_mov_b32 v82, 0
  v_mov_b32 v83, 0
  v_mov_b32 v84, 0
  v_mov_b32 v85, 0
  v_mov_b32 v86, 0
  v_mov_b32 v87, 0
  v_mov_b32 v88, 0
  v_mov_b32 v89, 0
  v_mov_b32 v90, 0
  v_mov_b32 v91, 0
  v_mov_b32 v92, 0
  v_mov_b32 v93, 0
  v_mov_b32 v94, 0
  v_mov_b32 v95, 0
  v_mov_b32 v96, 0
  v_mov_b32 v97, 0
  v_mov_b32 v98, 0
  v_mov_b32 v99, 0
  v_mov_b32 v100, 0
  v_mov_b32 v101, 0
  v_mov_b32 v102, 0
  v_mov_b32 v103, 0
  v_mov_b32 v104, 0
  v_mov_b32 v105, 0
  v_mov_b32 v106, 0
  v_mov_b32 v107, 0
  v_mov_b32 v108, 0
  v_mov_b32 v109, 0
  v_mov_b32 v110, 0
  v_mov_b32 v111, 0
  v_mov_b32 v112, 0
  v_mov_b32 v113, 0
  v_mov_b32 v114, 0
  v_mov_b32 v115, 0
  v_mov_b32 v116, 0
  v_mov_b32 v117, 0
  v_mov_b32 v118, 0
  v_mov_b32 v119, 0
  v_mov_b32 v120, 0
  v_mov_b32 v121, 0
  v_mov_b32 v122, 0
  v_mov_b32 v123, 0
  v_mov_b32 v124, 0
  v_mov_b32 v125, 0
  v_mov_b32 v126, 0
  v_mov_b32 v127, 0
  v_mov_b32 v128, 0
  v_mov_b32 v129, 0
  v_mov_b32 v130, 0
  v_mov_b32 v131, 0
  v_mov_b32 v132, 0
  v_mov_b32 v133, 0
  v_mov_b32 v134, 0
  v_mov_b32 v135, 0
  v_mov_b32 v136, 0
  v_mov_b32 v137, 0
  v_mov_b32 v138, 0
  v_mov_b32 v139, 0
  v_mov_b32 v140, 0
  v_mov_b32 v141, 0
  v_mov_b32 v142, 0
  v_mov_b32 v143, 0
  s_mov_b32 s52, 32768
  v_lshl_or_b32 v11, s26, 6, v0
  s_cmp_ge_u32 s26, 2
  s_cbranch_scc1 L3_nors
  s_lshl_b32 s40, s24, 13
  s_add_u32 s40, s40, 12386304
  v_lshlrev_b32 v12, 6, v11
  buffer_load_dwordx4 v[16:19], v12, s[16:19], s40 offen offset:0
  buffer_load_dwordx4 v[20:23], v12, s[16:19], s40 offen offset:16
  buffer_load_dwordx4 v[24:27], v12, s[16:19], s40 offen offset:32
  buffer_load_dwordx4 v[28:31], v12, s[16:19], s40 offen offset:48
  s_waitcnt vmcnt(0)
  v_add_f32 v16, v16, v18
  v_add_f32 v17, v17, v19
  v_add_f32 v16, v16, v20
  v_add_f32 v17, v17, v21
  v_add_f32 v16, v16, v22
  v_add_f32 v17, v17, v23
  v_add_f32 v16, v16, v24
  v_add_f32 v17, v17, v25
  v_add_f32 v16, v16, v26
  v_add_f32 v17, v17, v27
  v_add_f32 v16, v16, v28
  v_add_f32 v17, v17, v29
  v_add_f32 v16, v16, v30
  v_add_f32 v17, v17, v31
  s_mov_b32 s40, 0x3acccccd
  v_mul_f32 v16, s40, v16
  v_mul_f32 v17, s40, v17
  v_fma_f32 v17, -v16, v16, v17
  v_max_f32 v17, 0, v17
  v_add_f32 v17, 0x3727c5ac, v17
  v_rsq_f32 v17, v17
  v_lshlrev_b32 v12, 2, v11
  v_add_u32 v12, 133120, v12
  ds_write_b32 v12, v16
  ds_write_b32 v12, v17 offset:512
  s_branch L3_nors2
L3_nors:
  s_lshl_b32 s40, s25, 13
  s_add_u32 s40, s40, 20921856
  v_lshlrev_b32 v12, 2, v11
  buffer_load_dword v16, v12, s[16:19], s40 offen offset:0
  s_add_u32 s41, s40, 4096
  buffer_load_dword v17, v12, s[16:19], s40 offen offset:512
  buffer_load_dword v18, v12, s[16:19], s40 offen offset:1024
  buffer_load_dword v19, v12, s[16:19], s40 offen offset:1536
  buffer_load_dword v20, v12, s[16:19], s40 offen offset:2048
  buffer_load_dword v21, v12, s[16:19], s40 offen offset:2560
  buffer_load_dword v22, v12, s[16:19], s40 offen offset:3072
  buffer_load_dword v23, v12, s[16:19], s40 offen offset:3584
  buffer_load_dword v24, v12, s[16:19], s41 offen offset:0
  buffer_load_dword v25, v12, s[16:19], s41 offen offset:512
  buffer_load_dword v26, v12, s[16:19], s41 offen offset:1024
  buffer_load_dword v27, v12, s[16:19], s41 offen offset:1536
  buffer_load_dword v28, v12, s[16:19], s41 offen offset:2048
  buffer_load_dword v29, v12, s[16:19], s41 offen offset:2560
  buffer_load_dword v30, v12, s[16:19], s41 offen offset:3072
  buffer_load_dword v31, v12, s[16:19], s41 offen offset:3584
  s_waitcnt vmcnt(0)
  v_add_f32 v16, v16, v17
  v_add_f32 v16, v16, v18
  v_add_f32 v16, v16, v19
  v_add_f32 v16, v16, v20
  v_add_f32 v16, v16, v21
  v_add_f32 v16, v16, v22
  v_add_f32 v16, v16, v23
  v_add_f32 v16, v16, v24
  v_add_f32 v16, v16, v25
  v_add_f32 v16, v16, v26
  v_add_f32 v16, v16, v27
  v_add_f32 v16, v16, v28
  v_add_f32 v16, v16, v29
  v_add_f32 v16, v16, v30
  v_add_f32 v16, v16, v31
  v_add_u32 v12, 131584, v12
  ds_write_b32 v12, v16
L3_nors2:
  s_waitcnt lgkmcnt(0)
  s_barrier
  ds_read_b128 v[16:19], v2 offset:0
  ds_read_b128 v[20:23], v2 offset:2048
  ds_read_b128 v[24:27], v2 offset:4096
  ds_read_b128 v[28:31], v2 offset:6144
  ds_read_b64_tr_b16 v[32:33], v4 offset:0
  ds_read_b64_tr_b16 v[34:35], v4 offset:1024
  ds_read_b64_tr_b16 v[36:37], v5 offset:0
  ds_read_b64_tr_b16 v[38:39], v5 offset:1024
  ds_read_b64_tr_b16 v[40:41], v6 offset:0
  ds_read_b64_tr_b16 v[42:43], v6 offset:1024
  ds_read_b64_tr_b16 v[44:45], v7 offset:0
  ds_read_b64_tr_b16 v[46:47], v7 offset:1024
  s_mov_b32 s29, 0
  s_mov_b32 s30, 0
L3_loop0:
  s_add_u32 s30, s30, 32768
  s_cmp_eq_u32 s30, 131072
  s_cselect_b32 s40, -98304, s52
  s_cselect_b32 s30, 0, s30
  s_waitcnt lgkmcnt(0)
  v_mfma_f32_16x16x32_bf16 v[80:83], v[32:35], v[16:19], v[80:83]
  ds_read_b128 v[48:51], v3 offset:0
  v_mfma_f32_16x16x32_bf16 v[84:87], v[36:39], v[16:19], v[84:87]
  ds_read_b128 v[52:55], v3 offset:2048
  v_mfma_f32_16x16x32_bf16 v[88:91], v[40:43], v[16:19], v[88:91]
  ds_read_b128 v[56:59], v3 offset:4096
  v_mfma_f32_16x16x32_bf16 v[92:95], v[44:47], v[16:19], v[92:95]
  ds_read_b128 v[60:63], v3 offset:6144
  v_mfma_f32_16x16x32_bf16 v[96:99], v[32:35], v[20:23], v[96:99]
  ds_read_b64_tr_b16 v[64:65], v4 offset:8192
  v_mfma_f32_16x16x32_bf16 v[100:103], v[36:39], v[20:23], v[100:103]
  ds_read_b64_tr_b16 v[66:67], v4 offset:9216
  v_mfma_f32_16x16x32_bf16 v[104:107], v[40:43], v[20:23], v[104:107]
  ds_read_b64_tr_b16 v[68:69], v5 offset:8192
  v_mfma_f32_16x16x32_bf16 v[108:111], v[44:47], v[20:23], v[108:111]
  ds_read_b64_tr_b16 v[70:71], v5 offset:9216
  v_mfma_f32_16x16x32_bf16 v[112:115], v[32:35], v[24:27], v[112:115]
  ds_read_b64_tr_b16 v[72:73], v6 offset:8192
  v_mfma_f32_16x16x32_bf16 v[116:119], v[36:39], v[24:27], v[116:119]
  ds_read_b64_tr_b16 v[74:75], v6 offset:9216
  v_mfma_f32_16x16x32_bf16 v[120:123], v[40:43], v[24:27], v[120:123]
  ds_read_b64_tr_b16 v[76:77], v7 offset:8192
  v_mfma_f32_16x16x32_bf16 v[124:127], v[44:47], v[24:27], v[124:127]
  ds_read_b64_tr_b16 v[78:79], v7 offset:9216
  v_mfma_f32_16x16x32_bf16 v[128:131], v[32:35], v[28:31], v[128:131]
  v_add_u32 v2, s40, v2
  v_mfma_f32_16x16x32_bf16 v[132:135], v[36:39], v[28:31], v[132:135]
  v_add_u32 v3, s40, v3
  v_mfma_f32_16x16x32_bf16 v[136:139], v[40:43], v[28:31], v[136:139]
  v_add_u32 v4, s40, v4
  v_mfma_f32_16x16x32_bf16 v[140:143], v[44:47], v[28:31], v[140:143]
  v_add_u32 v5, s40, v5
  v_add_u32 v6, s40, v6
  v_add_u32 v7, s40, v7
  s_cmp_eq_u32 s29, 9
  s_cbranch_scc1 L3_last0
  s_add_u32 s29, s29, 1
  s_waitcnt lgkmcnt(0)
  s_barrier
  v_mfma_f32_16x16x32_bf16 v[80:83], v[64:67], v[48:51], v[80:83]
  ds_read_b128 v[16:19], v2 offset:0
  v_mfma_f32_16x16x32_bf16 v[84:87], v[68:71], v[48:51], v[84:87]
  ds_read_b128 v[20:23], v2 offset:2048
  v_mfma_f32_16x16x32_bf16 v[88:91], v[72:75], v[48:51], v[88:91]
  ds_read_b128 v[24:27], v2 offset:4096
  v_mfma_f32_16x16x32_bf16 v[92:95], v[76:79], v[48:51], v[92:95]
  ds_read_b128 v[28:31], v2 offset:6144
  v_mfma_f32_16x16x32_bf16 v[96:99], v[64:67], v[52:55], v[96:99]
  ds_read_b64_tr_b16 v[32:33], v4 offset:0
  v_mfma_f32_16x16x32_bf16 v[100:103], v[68:71], v[52:55], v[100:103]
  ds_read_b64_tr_b16 v[34:35], v4 offset:1024
  v_mfma_f32_16x16x32_bf16 v[104:107], v[72:75], v[52:55], v[104:107]
  ds_read_b64_tr_b16 v[36:37], v5 offset:0
  v_mfma_f32_16x16x32_bf16 v[108:111], v[76:79], v[52:55], v[108:111]
  ds_read_b64_tr_b16 v[38:39], v5 offset:1024
  v_mfma_f32_16x16x32_bf16 v[112:115], v[64:67], v[56:59], v[112:115]
  ds_read_b64_tr_b16 v[40:41], v6 offset:0
  v_mfma_f32_16x16x32_bf16 v[116:119], v[68:71], v[56:59], v[116:119]
  ds_read_b64_tr_b16 v[42:43], v6 offset:1024
  v_mfma_f32_16x16x32_bf16 v[120:123], v[72:75], v[56:59], v[120:123]
  ds_read_b64_tr_b16 v[44:45], v7 offset:0
  v_mfma_f32_16x16x32_bf16 v[124:127], v[76:79], v[56:59], v[124:127]
  ds_read_b64_tr_b16 v[46:47], v7 offset:1024
  v_mfma_f32_16x16x32_bf16 v[128:131], v[64:67], v[60:63], v[128:131]
  v_mfma_f32_16x16x32_bf16 v[132:135], v[68:71], v[60:63], v[132:135]
  v_mfma_f32_16x16x32_bf16 v[136:139], v[72:75], v[60:63], v[136:139]
  v_mfma_f32_16x16x32_bf16 v[140:143], v[76:79], v[60:63], v[140:143]
  s_branch L3_loop0
L3_last0:
  s_waitcnt lgkmcnt(0)
  v_mfma_f32_16x16x32_bf16 v[80:83], v[64:67], v[48:51], v[80:83]
  v_mfma_f32_16x16x32_bf16 v[84:87], v[68:71], v[48:51], v[84:87]
  v_mfma_f32_16x16x32_bf16 v[88:91], v[72:75], v[48:51], v[88:91]
  v_mfma_f32_16x16x32_bf16 v[92:95], v[76:79], v[48:51], v[92:95]
  v_mfma_f32_16x16x32_bf16 v[96:99], v[64:67], v[52:55], v[96:99]
  v_mfma_f32_16x16x32_bf16 v[100:103], v[68:71], v[52:55], v[100:103]
  v_mfma_f32_16x16x32_bf16 v[104:107], v[72:75], v[52:55], v[104:107]
  v_mfma_f32_16x16x32_bf16 v[108:111], v[76:79], v[52:55], v[108:111]
  v_mfma_f32_16x16x32_bf16 v[112:115], v[64:67], v[56:59], v[112:115]
  v_mfma_f32_16x16x32_bf16 v[116:119], v[68:71], v[56:59], v[116:119]
  v_mfma_f32_16x16x32_bf16 v[120:123], v[72:75], v[56:59], v[120:123]
  v_mfma_f32_16x16x32_bf16 v[124:127], v[76:79], v[56:59], v[124:127]
  v_mfma_f32_16x16x32_bf16 v[128:131], v[64:67], v[60:63], v[128:131]
  v_mfma_f32_16x16x32_bf16 v[132:135], v[68:71], v[60:63], v[132:135]
  v_mfma_f32_16x16x32_bf16 v[136:139], v[72:75], v[60:63], v[136:139]
  v_mfma_f32_16x16x32_bf16 v[140:143], v[76:79], v[60:63], v[140:143]
  s_mov_b32 s45, 0x3fb8aa3b
  v_and_b32 v8, 15, v0
  v_lshrrev_b32 v9, 4, v0
  s_lshl_b32 s40, s27, 8
  s_add_u32 s40, s40, 133120
  v_lshl_add_u32 v10, v8, 2, s40
  ds_read_b32 v16, v10 offset:0
  ds_read_b32 v24, v10 offset:512
  ds_read_b32 v18, v10 offset:64
  ds_read_b32 v26, v10 offset:576
  ds_read_b32 v20, v10 offset:128
  ds_read_b32 v28, v10 offset:640
  ds_read_b32 v22, v10 offset:192
  ds_read_b32 v30, v10 offset:704
  s_lshl_b32 s41, s28, 8
  s_add_u32 s41, s41, 132096
  v_lshl_add_u32 v11, v9, 4, s41
  ds_read_b128 v[32:35], v11 offset:0
  ds_read_b128 v[36:39], v11 offset:64
  ds_read_b128 v[40:43], v11 offset:128
  ds_read_b128 v[44:47], v11 offset:192
  v_lshrrev_b32 v10, 2, v8
  v_sub_u32 v10, 0, v10
  v_lshrrev_b32 v12, 1, v9
  v_xor_b32 v10, v10, v12
  v_and_b32 v10, 3, v10
  v_lshlrev_b32 v10, 4, v10
  v_lshl_add_u32 v10, v8, 6, v10
  v_and_b32 v12, 1, v9
  s_lshl_b32 s40, s24, 1
  s_add_u32 s40, s40, s27
  s_mul_i32 s40, s40, 221184
  s_add_u32 s40, s40, 5308416
  s_mul_i32 s41, s25, 224
  s_lshl_b32 s43, s28, 7
  s_add_u32 s43, s43, s41
  s_mov_b32 s50, s45
  s_mov_b32 s51, s45
  s_waitcnt lgkmcnt(0)
  v_pk_fma_f32 v[80:81], v[32:33], v[16:17], v[80:81] op_sel_hi:[1,0,1] neg_lo:[0,1,0] neg_hi:[0,1,0]
  v_pk_fma_f32 v[82:83], v[34:35], v[16:17], v[82:83] op_sel_hi:[1,0,1] neg_lo:[0,1,0] neg_hi:[0,1,0]
  v_pk_mul_f32 v[80:81], v[80:81], v[24:25] op_sel_hi:[1,0]
  v_pk_mul_f32 v[82:83], v[82:83], v[24:25] op_sel_hi:[1,0]
  v_pk_mul_f32 v[144:145], v[80:81], s[50:51]
  v_pk_mul_f32 v[146:147], v[82:83], s[50:51]
  v_exp_f32 v144, -v144
  v_exp_f32 v145, -v145
  v_exp_f32 v146, -v146
  v_exp_f32 v147, -v147
  v_pk_add_f32 v[144:145], v[144:145], 1.0 op_sel_hi:[1,0]
  v_pk_add_f32 v[146:147], v[146:147], 1.0 op_sel_hi:[1,0]
  v_rcp_f32 v144, v144
  v_rcp_f32 v145, v145
  v_rcp_f32 v146, v146
  v_rcp_f32 v147, v147
  s_nop 0
  v_pk_mul_f32 v[80:81], v[80:81], v[144:145]
  v_pk_mul_f32 v[82:83], v[82:83], v[146:147]
  v_cvt_pk_bf16_f32 v48, v80, v81
  v_cvt_pk_bf16_f32 v49, v82, v83
  v_pk_fma_f32 v[84:85], v[36:37], v[16:17], v[84:85] op_sel_hi:[1,0,1] neg_lo:[0,1,0] neg_hi:[0,1,0]
  v_pk_fma_f32 v[86:87], v[38:39], v[16:17], v[86:87] op_sel_hi:[1,0,1] neg_lo:[0,1,0] neg_hi:[0,1,0]
  v_pk_mul_f32 v[84:85], v[84:85], v[24:25] op_sel_hi:[1,0]
  v_pk_mul_f32 v[86:87], v[86:87], v[24:25] op_sel_hi:[1,0]
  v_pk_mul_f32 v[148:149], v[84:85], s[50:51]
  v_pk_mul_f32 v[150:151], v[86:87], s[50:51]
  v_exp_f32 v148, -v148
  v_exp_f32 v149, -v149
  v_exp_f32 v150, -v150
  v_exp_f32 v151, -v151
  v_pk_add_f32 v[148:149], v[148:149], 1.0 op_sel_hi:[1,0]
  v_pk_add_f32 v[150:151], v[150:151], 1.0 op_sel_hi:[1,0]
  v_rcp_f32 v148, v148
  v_rcp_f32 v149, v149
  v_rcp_f32 v150, v150
  v_rcp_f32 v151, v151
  s_nop 0
  v_pk_mul_f32 v[84:85], v[84:85], v[148:149]
  v_pk_mul_f32 v[86:87], v[86:87], v[150:151]
  v_cvt_pk_bf16_f32 v50, v84, v85
  v_cvt_pk_bf16_f32 v51, v86, v87
  s_nop 1
  v_permlane16_swap_b32 v48, v50
  v_permlane16_swap_b32 v49, v51
  v_pk_fma_f32 v[96:97], v[32:33], v[18:19], v[96:97] op_sel_hi:[1,0,1] neg_lo:[0,1,0] neg_hi:[0,1,0]
  v_pk_fma_f32 v[98:99], v[34:35], v[18:19], v[98:99] op_sel_hi:[1,0,1] neg_lo:[0,1,0] neg_hi:[0,1,0]
  v_pk_mul_f32 v[96:97], v[96:97], v[26:27] op_sel_hi:[1,0]
  v_pk_mul_f32 v[98:99], v[98:99], v[26:27] op_sel_hi:[1,0]
  v_pk_mul_f32 v[144:145], v[96:97], s[50:51]
  v_pk_mul_f32 v[146:147], v[98:99], s[50:51]
  v_exp_f32 v144, -v144
  v_exp_f32 v145, -v145
  v_exp_f32 v146, -v146
  v_exp_f32 v147, -v147
  v_pk_add_f32 v[144:145], v[144:145], 1.0 op_sel_hi:[1,0]
  v_pk_add_f32 v[146:147], v[146:147], 1.0 op_sel_hi:[1,0]
  v_rcp_f32 v144, v144
  v_rcp_f32 v145, v145
  v_rcp_f32 v146, v146
  v_rcp_f32 v147, v147
  s_nop 0
  v_pk_mul_f32 v[96:97], v[96:97], v[144:145]
  v_pk_mul_f32 v[98:99], v[98:99], v[146:147]
  v_cvt_pk_bf16_f32 v52, v96, v97
  v_cvt_pk_bf16_f32 v53, v98, v99
  v_pk_fma_f32 v[100:101], v[36:37], v[18:19], v[100:101] op_sel_hi:[1,0,1] neg_lo:[0,1,0] neg_hi:[0,1,0]
  v_pk_fma_f32 v[102:103], v[38:39], v[18:19], v[102:103] op_sel_hi:[1,0,1] neg_lo:[0,1,0] neg_hi:[0,1,0]
  v_pk_mul_f32 v[100:101], v[100:101], v[26:27] op_sel_hi:[1,0]
  v_pk_mul_f32 v[102:103], v[102:103], v[26:27] op_sel_hi:[1,0]
  v_pk_mul_f32 v[148:149], v[100:101], s[50:51]
  v_pk_mul_f32 v[150:151], v[102:103], s[50:51]
  v_exp_f32 v148, -v148
  v_exp_f32 v149, -v149
  v_exp_f32 v150, -v150
  v_exp_f32 v151, -v151
  v_pk_add_f32 v[148:149], v[148:149], 1.0 op_sel_hi:[1,0]
  v_pk_add_f32 v[150:151], v[150:151], 1.0 op_sel_hi:[1,0]
  v_rcp_f32 v148, v148
  v_rcp_f32 v149, v149
  v_rcp_f32 v150, v150
  v_rcp_f32 v151, v151
  s_nop 0
  v_pk_mul_f32 v[100:101], v[100:101], v[148:149]
  v_pk_mul_f32 v[102:103], v[102:103], v[150:151]
  v_cvt_pk_bf16_f32 v54, v100, v101
  v_cvt_pk_bf16_f32 v55, v102, v103
  s_nop 1
  v_permlane16_swap_b32 v52, v54
  v_permlane16_swap_b32 v53, v55
  v_pk_fma_f32 v[112:113], v[32:33], v[20:21], v[112:113] op_sel_hi:[1,0,1] neg_lo:[0,1,0] neg_hi:[0,1,0]
  v_pk_fma_f32 v[114:115], v[34:35], v[20:21], v[114:115] op_sel_hi:[1,0,1] neg_lo:[0,1,0] neg_hi:[0,1,0]
  v_pk_mul_f32 v[112:113], v[112:113], v[28:29] op_sel_hi:[1,0]
  v_pk_mul_f32 v[114:115], v[114:115], v[28:29] op_sel_hi:[1,0]
  v_pk_mul_f32 v[144:145], v[112:113], s[50:51]
  v_pk_mul_f32 v[146:147], v[114:115], s[50:51]
  v_exp_f32 v144, -v144
  v_exp_f32 v145, -v145
  v_exp_f32 v146, -v146
  v_exp_f32 v147, -v147
  v_pk_add_f32 v[144:145], v[144:145], 1.0 op_sel_hi:[1,0]
  v_pk_add_f32 v[146:147], v[146:147], 1.0 op_sel_hi:[1,0]
  v_rcp_f32 v144, v144
  v_rcp_f32 v145, v145
  v_rcp_f32 v146, v146
  v_rcp_f32 v147, v147
  s_nop 0
  v_pk_mul_f32 v[112:113], v[112:113], v[144:145]
  v_pk_mul_f32 v[114:115], v[114:115], v[146:147]
  v_cvt_pk_bf16_f32 v56, v112, v113
  v_cvt_pk_bf16_f32 v57, v114, v115
  v_pk_fma_f32 v[116:117], v[36:37], v[20:21], v[116:117] op_sel_hi:[1,0,1] neg_lo:[0,1,0] neg_hi:[0,1,0]
  v_pk_fma_f32 v[118:119], v[38:39], v[20:21], v[118:119] op_sel_hi:[1,0,1] neg_lo:[0,1,0] neg_hi:[0,1,0]
  v_pk_mul_f32 v[116:117], v[116:117], v[28:29] op_sel_hi:[1,0]
  v_pk_mul_f32 v[118:119], v[118:119], v[28:29] op_sel_hi:[1,0]
  v_pk_mul_f32 v[148:149], v[116:117], s[50:51]
  v_pk_mul_f32 v[150:151], v[118:119], s[50:51]
  v_exp_f32 v148, -v148
  v_exp_f32 v149, -v149
  v_exp_f32 v150, -v150
  v_exp_f32 v151, -v151
  v_pk_add_f32 v[148:149], v[148:149], 1.0 op_sel_hi:[1,0]
  v_pk_add_f32 v[150:151], v[150:151], 1.0 op_sel_hi:[1,0]
  v_rcp_f32 v148, v148
  v_rcp_f32 v149, v149
  v_rcp_f32 v150, v150
  v_rcp_f32 v151, v151
  s_nop 0
  v_pk_mul_f32 v[116:117], v[116:117], v[148:149]
  v_pk_mul_f32 v[118:119], v[118:119], v[150:151]
  v_cvt_pk_bf16_f32 v58, v116, v117
  v_cvt_pk_bf16_f32 v59, v118, v119
  s_nop 1
  v_permlane16_swap_b32 v56, v58
  v_permlane16_swap_b32 v57, v59
  v_pk_fma_f32 v[128:129], v[32:33], v[22:23], v[128:129] op_sel_hi:[1,0,1] neg_lo:[0,1,0] neg_hi:[0,1,0]
  v_pk_fma_f32 v[130:131], v[34:35], v[22:23], v[130:131] op_sel_hi:[1,0,1] neg_lo:[0,1,0] neg_hi:[0,1,0]
  v_pk_mul_f32 v[128:129], v[128:129], v[30:31] op_sel_hi:[1,0]
  v_pk_mul_f32 v[130:131], v[130:131], v[30:31] op_sel_hi:[1,0]
  v_pk_mul_f32 v[144:145], v[128:129], s[50:51]
  v_pk_mul_f32 v[146:147], v[130:131], s[50:51]
  v_exp_f32 v144, -v144
  v_exp_f32 v145, -v145
  v_exp_f32 v146, -v146
  v_exp_f32 v147, -v147
  v_pk_add_f32 v[144:145], v[144:145], 1.0 op_sel_hi:[1,0]
  v_pk_add_f32 v[146:147], v[146:147], 1.0 op_sel_hi:[1,0]
  v_rcp_f32 v144, v144
  v_rcp_f32 v145, v145
  v_rcp_f32 v146, v146
  v_rcp_f32 v147, v147
  s_nop 0
  v_pk_mul_f32 v[128:129], v[128:129], v[144:145]
  v_pk_mul_f32 v[130:131], v[130:131], v[146:147]
  v_cvt_pk_bf16_f32 v60, v128, v129
  v_cvt_pk_bf16_f32 v61, v130, v131
  v_pk_fma_f32 v[132:133], v[36:37], v[22:23], v[132:133] op_sel_hi:[1,0,1] neg_lo:[0,1,0] neg_hi:[0,1,0]
  v_pk_fma_f32 v[134:135], v[38:39], v[22:23], v[134:135] op_sel_hi:[1,0,1] neg_lo:[0,1,0] neg_hi:[0,1,0]
  v_pk_mul_f32 v[132:133], v[132:133], v[30:31] op_sel_hi:[1,0]
  v_pk_mul_f32 v[134:135], v[134:135], v[30:31] op_sel_hi:[1,0]
  v_pk_mul_f32 v[148:149], v[132:133], s[50:51]
  v_pk_mul_f32 v[150:151], v[134:135], s[50:51]
  v_exp_f32 v148, -v148
  v_exp_f32 v149, -v149
  v_exp_f32 v150, -v150
  v_exp_f32 v151, -v151
  v_pk_add_f32 v[148:149], v[148:149], 1.0 op_sel_hi:[1,0]
  v_pk_add_f32 v[150:151], v[150:151], 1.0 op_sel_hi:[1,0]
  v_rcp_f32 v148, v148
  v_rcp_f32 v149, v149
  v_rcp_f32 v150, v150
  v_rcp_f32 v151, v151
  s_nop 0
  v_pk_mul_f32 v[132:133], v[132:133], v[148:149]
  v_pk_mul_f32 v[134:135], v[134:135], v[150:151]
  v_cvt_pk_bf16_f32 v62, v132, v133
  v_cvt_pk_bf16_f32 v63, v134, v135
  s_nop 1
  v_permlane16_swap_b32 v60, v62
  v_permlane16_swap_b32 v61, v63
  s_add_u32 s46, s43, 0
  v_lshl_add_u32 v11, v12, 5, s46
  v_lshrrev_b32 v152, 6, v11
  v_lshlrev_b32 v152, 12, v152
  v_and_b32 v153, 32, v11
  v_xor_b32 v153, v153, v10
  v_add_u32 v152, v152, v153
  v_cmp_gt_u32 vcc, 3456, v11
  v_subrev_u32 v153, s41, v11
  s_mov_b64 s[48:49], vcc
  v_cmp_gt_u32 vcc, 224, v153
  s_and_b64 vcc, vcc, s[48:49]
  v_mov_b32 v153, 0x7fffffff
  v_cndmask_b32 v152, v153, v152, vcc
  buffer_store_dwordx4 v[48:51], v152, s[16:19], s40 offen offset:0
  buffer_store_dwordx4 v[52:55], v152, s[16:19], s40 offen offset:1024
  buffer_store_dwordx4 v[56:59], v152, s[16:19], s40 offen offset:2048
  buffer_store_dwordx4 v[60:63], v152, s[16:19], s40 offen offset:3072
  v_pk_fma_f32 v[88:89], v[40:41], v[16:17], v[88:89] op_sel_hi:[1,0,1] neg_lo:[0,1,0] neg_hi:[0,1,0]
  v_pk_fma_f32 v[90:91], v[42:43], v[16:17], v[90:91] op_sel_hi:[1,0,1] neg_lo:[0,1,0] neg_hi:[0,1,0]
  v_pk_mul_f32 v[88:89], v[88:89], v[24:25] op_sel_hi:[1,0]
  v_pk_mul_f32 v[90:91], v[90:91], v[24:25] op_sel_hi:[1,0]
  v_pk_mul_f32 v[144:145], v[88:89], s[50:51]
  v_pk_mul_f32 v[146:147], v[90:91], s[50:51]
  v_exp_f32 v144, -v144
  v_exp_f32 v145, -v145
  v_exp_f32 v146, -v146
  v_exp_f32 v147, -v147
  v_pk_add_f32 v[144:145], v[144:145], 1.0 op_sel_hi:[1,0]
  v_pk_add_f32 v[146:147], v[146:147], 1.0 op_sel_hi:[1,0]
  v_rcp_f32 v144, v144
  v_rcp_f32 v145, v145
  v_rcp_f32 v146, v146
  v_rcp_f32 v147, v147
  s_nop 0
  v_pk_mul_f32 v[88:89], v[88:89], v[144:145]
  v_pk_mul_f32 v[90:91], v[90:91], v[146:147]
  v_cvt_pk_bf16_f32 v64, v88, v89
  v_cvt_pk_bf16_f32 v65, v90, v91
  v_pk_fma_f32 v[92:93], v[44:45], v[16:17], v[92:93] op_sel_hi:[1,0,1] neg_lo:[0,1,0] neg_hi:[0,1,0]
  v_pk_fma_f32 v[94:95], v[46:47], v[16:17], v[94:95] op_sel_hi:[1,0,1] neg_lo:[0,1,0] neg_hi:[0,1,0]
  v_pk_mul_f32 v[92:93], v[92:93], v[24:25] op_sel_hi:[1,0]
  v_pk_mul_f32 v[94:95], v[94:95], v[24:25] op_sel_hi:[1,0]
  v_pk_mul_f32 v[148:149], v[92:93], s[50:51]
  v_pk_mul_f32 v[150:151], v[94:95], s[50:51]
  v_exp_f32 v148, -v148
  v_exp_f32 v149, -v149
  v_exp_f32 v150, -v150
  v_exp_f32 v151, -v151
  v_pk_add_f32 v[148:149], v[148:149], 1.0 op_sel_hi:[1,0]
  v_pk_add_f32 v[150:151], v[150:151], 1.0 op_sel_hi:[1,0]
  v_rcp_f32 v148, v148
  v_rcp_f32 v149, v149
  v_rcp_f32 v150, v150
  v_rcp_f32 v151, v151
  s_nop 0
  v_pk_mul_f32 v[92:93], v[92:93], v[148:149]
  v_pk_mul_f32 v[94:95], v[94:95], v[150:151]
  v_cvt_pk_bf16_f32 v66, v92, v93
  v_cvt_pk_bf16_f32 v67, v94, v95
  s_nop 1
  v_permlane16_swap_b32 v64, v66
  v_permlane16_swap_b32 v65, v67
  v_pk_fma_f32 v[104:105], v[40:41], v[18:19], v[104:105] op_sel_hi:[1,0,1] neg_lo:[0,1,0] neg_hi:[0,1,0]
  v_pk_fma_f32 v[106:107], v[42:43], v[18:19], v[106:107] op_sel_hi:[1,0,1] neg_lo:[0,1,0] neg_hi:[0,1,0]
  v_pk_mul_f32 v[104:105], v[104:105], v[26:27] op_sel_hi:[1,0]
  v_pk_mul_f32 v[106:107], v[106:107], v[26:27] op_sel_hi:[1,0]
  v_pk_mul_f32 v[144:145], v[104:105], s[50:51]
  v_pk_mul_f32 v[146:147], v[106:107], s[50:51]
  v_exp_f32 v144, -v144
  v_exp_f32 v145, -v145
  v_exp_f32 v146, -v146
  v_exp_f32 v147, -v147
  v_pk_add_f32 v[144:145], v[144:145], 1.0 op_sel_hi:[1,0]
  v_pk_add_f32 v[146:147], v[146:147], 1.0 op_sel_hi:[1,0]
  v_rcp_f32 v144, v144
  v_rcp_f32 v145, v145
  v_rcp_f32 v146, v146
  v_rcp_f32 v147, v147
  s_nop 0
  v_pk_mul_f32 v[104:105], v[104:105], v[144:145]
  v_pk_mul_f32 v[106:107], v[106:107], v[146:147]
  v_cvt_pk_bf16_f32 v68, v104, v105
  v_cvt_pk_bf16_f32 v69, v106, v107
  v_pk_fma_f32 v[108:109], v[44:45], v[18:19], v[108:109] op_sel_hi:[1,0,1] neg_lo:[0,1,0] neg_hi:[0,1,0]
  v_pk_fma_f32 v[110:111], v[46:47], v[18:19], v[110:111] op_sel_hi:[1,0,1] neg_lo:[0,1,0] neg_hi:[0,1,0]
  v_pk_mul_f32 v[108:109], v[108:109], v[26:27] op_sel_hi:[1,0]
  v_pk_mul_f32 v[110:111], v[110:111], v[26:27] op_sel_hi:[1,0]
  v_pk_mul_f32 v[148:149], v[108:109], s[50:51]
  v_pk_mul_f32 v[150:151], v[110:111], s[50:51]
  v_exp_f32 v148, -v148
  v_exp_f32 v149, -v149
  v_exp_f32 v150, -v150
  v_exp_f32 v151, -v151
  v_pk_add_f32 v[148:149], v[148:149], 1.0 op_sel_hi:[1,0]
  v_pk_add_f32 v[150:151], v[150:151], 1.0 op_sel_hi:[1,0]
  v_rcp_f32 v148, v148
  v_rcp_f32 v149, v149
  v_rcp_f32 v150, v150
  v_rcp_f32 v151, v151
  s_nop 0
  v_pk_mul_f32 v[108:109], v[108:109], v[148:149]
  v_pk_mul_f32 v[110:111], v[110:111], v[150:151]
  v_cvt_pk_bf16_f32 v70, v108, v109
  v_cvt_pk_bf16_f32 v71, v110, v111
  s_nop 1
  v_permlane16_swap_b32 v68, v70
  v_permlane16_swap_b32 v69, v71
  v_pk_fma_f32 v[120:121], v[40:41], v[20:21], v[120:121] op_sel_hi:[1,0,1] neg_lo:[0,1,0] neg_hi:[0,1,0]
  v_pk_fma_f32 v[122:123], v[42:43], v[20:21], v[122:123] op_sel_hi:[1,0,1] neg_lo:[0,1,0] neg_hi:[0,1,0]
  v_pk_mul_f32 v[120:121], v[120:121], v[28:29] op_sel_hi:[1,0]
  v_pk_mul_f32 v[122:123], v[122:123], v[28:29] op_sel_hi:[1,0]
  v_pk_mul_f32 v[144:145], v[120:121], s[50:51]
  v_pk_mul_f32 v[146:147], v[122:123], s[50:51]
  v_exp_f32 v144, -v144
  v_exp_f32 v145, -v145
  v_exp_f32 v146, -v146
  v_exp_f32 v147, -v147
  v_pk_add_f32 v[144:145], v[144:145], 1.0 op_sel_hi:[1,0]
  v_pk_add_f32 v[146:147], v[146:147], 1.0 op_sel_hi:[1,0]
  v_rcp_f32 v144, v144
  v_rcp_f32 v145, v145
  v_rcp_f32 v146, v146
  v_rcp_f32 v147, v147
  s_nop 0
  v_pk_mul_f32 v[120:121], v[120:121], v[144:145]
  v_pk_mul_f32 v[122:123], v[122:123], v[146:147]
  v_cvt_pk_bf16_f32 v72, v120, v121
  v_cvt_pk_bf16_f32 v73, v122, v123
  v_pk_fma_f32 v[124:125], v[44:45], v[20:21], v[124:125] op_sel_hi:[1,0,1] neg_lo:[0,1,0] neg_hi:[0,1,0]
  v_pk_fma_f32 v[126:127], v[46:47], v[20:21], v[126:127] op_sel_hi:[1,0,1] neg_lo:[0,1,0] neg_hi:[0,1,0]
  v_pk_mul_f32 v[124:125], v[124:125], v[28:29] op_sel_hi:[1,0]
  v_pk_mul_f32 v[126:127], v[126:127], v[28:29] op_sel_hi:[1,0]
  v_pk_mul_f32 v[148:149], v[124:125], s[50:51]
  v_pk_mul_f32 v[150:151], v[126:127], s[50:51]
  v_exp_f32 v148, -v148
  v_exp_f32 v149, -v149
  v_exp_f32 v150, -v150
  v_exp_f32 v151, -v151
  v_pk_add_f32 v[148:149], v[148:149], 1.0 op_sel_hi:[1,0]
  v_pk_add_f32 v[150:151], v[150:151], 1.0 op_sel_hi:[1,0]
  v_rcp_f32 v148, v148
  v_rcp_f32 v149, v149
  v_rcp_f32 v150, v150
  v_rcp_f32 v151, v151
  s_nop 0
  v_pk_mul_f32 v[124:125], v[124:125], v[148:149]
  v_pk_mul_f32 v[126:127], v[126:127], v[150:151]
  v_cvt_pk_bf16_f32 v74, v124, v125
  v_cvt_pk_bf16_f32 v75, v126, v127
  s_nop 1
  v_permlane16_swap_b32 v72, v74
  v_permlane16_swap_b32 v73, v75
  v_pk_fma_f32 v[136:137], v[40:41], v[22:23], v[136:137] op_sel_hi:[1,0,1] neg_lo:[0,1,0] neg_hi:[0,1,0]
  v_pk_fma_f32 v[138:139], v[42:43], v[22:23], v[138:139] op_sel_hi:[1,0,1] neg_lo:[0,1,0] neg_hi:[0,1,0]
  v_pk_mul_f32 v[136:137], v[136:137], v[30:31] op_sel_hi:[1,0]
  v_pk_mul_f32 v[138:139], v[138:139], v[30:31] op_sel_hi:[1,0]
  v_pk_mul_f32 v[144:145], v[136:137], s[50:51]
  v_pk_mul_f32 v[146:147], v[138:139], s[50:51]
  v_exp_f32 v144, -v144
  v_exp_f32 v145, -v145
  v_exp_f32 v146, -v146
  v_exp_f32 v147, -v147
  v_pk_add_f32 v[144:145], v[144:145], 1.0 op_sel_hi:[1,0]
  v_pk_add_f32 v[146:147], v[146:147], 1.0 op_sel_hi:[1,0]
  v_rcp_f32 v144, v144
  v_rcp_f32 v145, v145
  v_rcp_f32 v146, v146
  v_rcp_f32 v147, v147
  s_nop 0
  v_pk_mul_f32 v[136:137], v[136:137], v[144:145]
  v_pk_mul_f32 v[138:139], v[138:139], v[146:147]
  v_cvt_pk_bf16_f32 v76, v136, v137
  v_cvt_pk_bf16_f32 v77, v138, v139
  v_pk_fma_f32 v[140:141], v[44:45], v[22:23], v[140:141] op_sel_hi:[1,0,1] neg_lo:[0,1,0] neg_hi:[0,1,0]
  v_pk_fma_f32 v[142:143], v[46:47], v[22:23], v[142:143] op_sel_hi:[1,0,1] neg_lo:[0,1,0] neg_hi:[0,1,0]
  v_pk_mul_f32 v[140:141], v[140:141], v[30:31] op_sel_hi:[1,0]
  v_pk_mul_f32 v[142:143], v[142:143], v[30:31] op_sel_hi:[1,0]
  v_pk_mul_f32 v[148:149], v[140:141], s[50:51]
  v_pk_mul_f32 v[150:151], v[142:143], s[50:51]
  v_exp_f32 v148, -v148
  v_exp_f32 v149, -v149
  v_exp_f32 v150, -v150
  v_exp_f32 v151, -v151
  v_pk_add_f32 v[148:149], v[148:149], 1.0 op_sel_hi:[1,0]
  v_pk_add_f32 v[150:151], v[150:151], 1.0 op_sel_hi:[1,0]
  v_rcp_f32 v148, v148
  v_rcp_f32 v149, v149
  v_rcp_f32 v150, v150
  v_rcp_f32 v151, v151
  s_nop 0
  v_pk_mul_f32 v[140:141], v[140:141], v[148:149]
  v_pk_mul_f32 v[142:143], v[142:143], v[150:151]
  v_cvt_pk_bf16_f32 v78, v140, v141
  v_cvt_pk_bf16_f32 v79, v142, v143
  s_nop 1
  v_permlane16_swap_b32 v76, v78
  v_permlane16_swap_b32 v77, v79
  s_add_u32 s46, s43, 64
  v_lshl_add_u32 v11, v12, 5, s46
  v_lshrrev_b32 v152, 6, v11
  v_lshlrev_b32 v152, 12, v152
  v_and_b32 v153, 32, v11
  v_xor_b32 v153, v153, v10
  v_add_u32 v152, v152, v153
  v_cmp_gt_u32 vcc, 3456, v11
  v_subrev_u32 v153, s41, v11
  s_mov_b64 s[48:49], vcc
  v_cmp_gt_u32 vcc, 224, v153
  s_and_b64 vcc, vcc, s[48:49]
  v_mov_b32 v153, 0x7fffffff
  v_cndmask_b32 v152, v153, v152, vcc
  buffer_store_dwordx4 v[64:67], v152, s[16:19], s40 offen offset:0
  buffer_store_dwordx4 v[68:71], v152, s[16:19], s40 offen offset:1024
  buffer_store_dwordx4 v[72:75], v152, s[16:19], s40 offen offset:2048
  buffer_store_dwordx4 v[76:79], v152, s[16:19], s40 offen offset:3072
  s_branch L3_done
L3_loader:
  s_sub_u32 s27, s26, 4
  v_lshrrev_b32 v8, 3, v0
  v_and_b32 v9, 7, v0
  v_xor_b32 v9, v9, v8
  v_lshlrev_b32 v9, 4, v9
  s_lshl_b32 s40, s24, 7
  s_lshl_b32 s41, s27, 4
  s_add_u32 s40, s40, s41
  v_add_u32 v8, s40, v8
  s_movk_i32 s41, 1280
  v_mad_u32_u24 v2, v8, s41, v9
  v_add_u32 v3, 9216, v2
  v_lshrrev_b32 v8, 4, v0
  v_and_b32 v9, 15, v0
  s_lshl_b32 s40, s27, 3
  v_add_u32 v12, s40, v8
  s_and_b32 s40, s27, 1
  s_lshl_b32 s40, s40, 2
  v_add_u32 v8, s40, v8
  v_lshrrev_b32 v10, 1, v9
  v_xor_b32 v10, v10, v8
  v_lshlrev_b32 v10, 1, v10
  v_and_b32 v11, 1, v9
  v_or_b32 v10, v10, v11
  v_lshlrev_b32 v11, 4, v10
  s_mul_i32 s42, s25, 224
  s_mul_i32 s42, s25, 163840
  s_lshl_b32 s41, s27, 11
  s_add_u32 s42, s42, s41
  v_lshlrev_b32 v4, 4, v0
  v_add_u32 v4, s42, v4
  v_mov_b32 v5, v4
  s_lshl_b32 s34, s27, 11
  s_mov_b32 s31, 0
  s_mov_b32 s32, 0
  s_mov_b32 s33, 0
  s_add_u32 s35, s31, s34
  s_mov_b32 m0, s35
  s_add_u32 s35, s35, 16384
  buffer_load_dwordx4 v2, s[8:11], s32 offen offset:0 lds
  buffer_load_dwordx4 v3, s[8:11], s32 offen offset:1024 lds
  s_mov_b32 m0, s35
  s_add_u32 s32, s32, 128
  buffer_load_dwordx4 v4, s[12:15], s33 offen offset:0 lds
  buffer_load_dwordx4 v5, s[12:15], s33 offen offset:1024 lds
  s_add_u32 s33, s33, 16384
  s_add_u32 s31, s31, 32768
  s_cmp_eq_u32 s31, 131072
  s_cselect_b32 s31, 0, s31
  s_add_u32 s35, s31, s34
  s_mov_b32 m0, s35
  s_add_u32 s35, s35, 16384
  buffer_load_dwordx4 v2, s[8:11], s32 offen offset:0 lds
  buffer_load_dwordx4 v3, s[8:11], s32 offen offset:1024 lds
  s_mov_b32 m0, s35
  s_add_u32 s32, s32, 128
  buffer_load_dwordx4 v4, s[12:15], s33 offen offset:0 lds
  buffer_load_dwordx4 v5, s[12:15], s33 offen offset:1024 lds
  s_add_u32 s33, s33, 16384
  s_add_u32 s31, s31, 32768
  s_cmp_eq_u32 s31, 131072
  s_cselect_b32 s31, 0, s31
  s_add_u32 s35, s31, s34
  s_mov_b32 m0, s35
  s_add_u32 s35, s35, 16384
  buffer_load_dwordx4 v2, s[8:11], s32 offen offset:0 lds
  buffer_load_dwordx4 v3, s[8:11], s32 offen offset:1024 lds
  s_mov_b32 m0, s35
  s_add_u32 s32, s32, 128
  buffer_load_dwordx4 v4, s[12:15], s33 offen offset:0 lds
  buffer_load_dwordx4 v5, s[12:15], s33 offen offset:1024 lds
  s_add_u32 s33, s33, 16384
  s_add_u32 s31, s31, 32768
  s_cmp_eq_u32 s31, 131072
  s_cselect_b32 s31, 0, s31
  s_add_u32 s35, s31, s34
  s_mov_b32 m0, s35
  s_add_u32 s35, s35, 16384
  buffer_load_dwordx4 v2, s[8:11], s32 offen offset:0 lds
  buffer_load_dwordx4 v3, s[8:11], s32 offen offset:1024 lds
  s_mov_b32 m0, s35
  s_add_u32 s32, s32, 128
  buffer_load_dwordx4 v4, s[12:15], s33 offen offset:0 lds
  buffer_load_dwordx4 v5, s[12:15], s33 offen offset:1024 lds
  s_add_u32 s33, s33, 16384
  s_add_u32 s31, s31, 32768
  s_cmp_eq_u32 s31, 131072
  s_cselect_b32 s31, 0, s31

L3_PFRET:
  s_mov_b64 exec, -1
  s_waitcnt vmcnt(12)
  s_barrier
  s_waitcnt vmcnt(8)
  s_barrier
  s_add_u32 s35, s31, s34
  s_mov_b32 m0, s35
  s_add_u32 s35, s35, 16384
  buffer_load_dwordx4 v2, s[8:11], s32 offen offset:0 lds
  buffer_load_dwordx4 v3, s[8:11], s32 offen offset:1024 lds
  s_mov_b32 m0, s35
  s_add_u32 s32, s32, 128
  buffer_load_dwordx4 v4, s[12:15], s33 offen offset:0 lds
  buffer_load_dwordx4 v5, s[12:15], s33 offen offset:1024 lds
  s_add_u32 s33, s33, 16384
  s_add_u32 s31, s31, 32768
  s_cmp_eq_u32 s31, 131072
  s_cselect_b32 s31, 0, s31
  s_waitcnt vmcnt(8)
  s_barrier
  s_add_u32 s35, s31, s34
  s_mov_b32 m0, s35
  s_add_u32 s35, s35, 16384
  buffer_load_dwordx4 v2, s[8:11], s32 offen offset:0 lds
  buffer_load_dwordx4 v3, s[8:11], s32 offen offset:1024 lds
  s_mov_b32 m0, s35
  s_add_u32 s32, s32, 128
  buffer_load_dwordx4 v4, s[12:15], s33 offen offset:0 lds
  buffer_load_dwordx4 v5, s[12:15], s33 offen offset:1024 lds
  s_add_u32 s33, s33, 16384
  s_add_u32 s31, s31, 32768
  s_cmp_eq_u32 s31, 131072
  s_cselect_b32 s31, 0, s31
  s_waitcnt vmcnt(8)
  s_barrier
  s_add_u32 s35, s31, s34
  s_mov_b32 m0, s35
  s_add_u32 s35, s35, 16384
  buffer_load_dwordx4 v2, s[8:11], s32 offen offset:0 lds
  buffer_load_dwordx4 v3, s[8:11], s32 offen offset:1024 lds
  s_mov_b32 m0, s35
  s_add_u32 s32, s32, 128
  buffer_load_dwordx4 v4, s[12:15], s33 offen offset:0 lds
  buffer_load_dwordx4 v5, s[12:15], s33 offen offset:1024 lds
  s_add_u32 s33, s33, 16384
  s_add_u32 s31, s31, 32768
  s_cmp_eq_u32 s31, 131072
  s_cselect_b32 s31, 0, s31
  s_waitcnt vmcnt(8)
  s_barrier
  s_add_u32 s35, s31, s34
  s_mov_b32 m0, s35
  s_add_u32 s35, s35, 16384
  buffer_load_dwordx4 v2, s[8:11], s32 offen offset:0 lds
  buffer_load_dwordx4 v3, s[8:11], s32 offen offset:1024 lds
  s_mov_b32 m0, s35
  s_add_u32 s32, s32, 128
  buffer_load_dwordx4 v4, s[12:15], s33 offen offset:0 lds
  buffer_load_dwordx4 v5, s[12:15], s33 offen offset:1024 lds
  s_add_u32 s33, s33, 16384
  s_add_u32 s31, s31, 32768
  s_cmp_eq_u32 s31, 131072
  s_cselect_b32 s31, 0, s31
  s_waitcnt vmcnt(8)
  s_barrier
  s_add_u32 s35, s31, s34
  s_mov_b32 m0, s35
  s_add_u32 s35, s35, 16384
  buffer_load_dwordx4 v2, s[8:11], s32 offen offset:0 lds
  buffer_load_dwordx4 v3, s[8:11], s32 offen offset:1024 lds
  s_mov_b32 m0, s35
  s_add_u32 s32, s32, 128
  buffer_load_dwordx4 v4, s[12:15], s33 offen offset:0 lds
  buffer_load_dwordx4 v5, s[12:15], s33 offen offset:1024 lds
  s_add_u32 s33, s33, 16384
  s_add_u32 s31, s31, 32768
  s_cmp_eq_u32 s31, 131072
  s_cselect_b32 s31, 0, s31
  s_waitcnt vmcnt(8)
  s_barrier
  s_add_u32 s35, s31, s34
  s_mov_b32 m0, s35
  s_add_u32 s35, s35, 16384
  buffer_load_dwordx4 v2, s[8:11], s32 offen offset:0 lds
  buffer_load_dwordx4 v3, s[8:11], s32 offen offset:1024 lds
  s_mov_b32 m0, s35
  s_add_u32 s32, s32, 128
  buffer_load_dwordx4 v4, s[12:15], s33 offen offset:0 lds
  buffer_load_dwordx4 v5, s[12:15], s33 offen offset:1024 lds
  s_add_u32 s33, s33, 16384
  s_add_u32 s31, s31, 32768
  s_cmp_eq_u32 s31, 131072
  s_cselect_b32 s31, 0, s31
  s_waitcnt vmcnt(8)
  s_barrier
  s_waitcnt vmcnt(4)
  s_barrier
  s_waitcnt vmcnt(0)
  s_barrier
L3_done:
  s_endpgm
.globl k4_ffn2_kernel
.p2align 8
.type k4_ffn2_kernel,@function
k4_ffn2_kernel:
  s_cmp_ge_u32 s2, 256
  s_cbranch_scc1 L4_done
  s_load_dwordx4 s[36:39], s[0:1], 56
  s_load_dwordx2 s[4:5], s[0:1], 48
  s_load_dwordx2 s[6:7], s[0:1], 40
  s_load_dwordx2 s[42:43], s[0:1], 0
  s_and_b32 s40, s2, 7
  s_lshr_b32 s41, s2, 3
  s_lshr_b32 s24, s40, 1
  s_lshl_b32 s24, s24, 3
  s_and_b32 s44, s41, 7
  s_add_u32 s24, s24, s44
  s_and_b32 s25, s40, 1
  s_lshl_b32 s25, s25, 2
  s_lshr_b32 s44, s41, 3
  s_add_u32 s25, s25, s44
  v_lshrrev_b32 v1, 6, v0
  v_mov_b32 v2, v0
  v_and_b32 v0, 63, v0
  v_readfirstlane_b32 s26, v1
  s_nop 3
  s_mul_i32 s40, s24, 221184
  s_add_u32 s40, s40, 5308416
  s_mul_i32 s41, s25, 276480
  s_add_u32 s41, s41, 15138816
  s_waitcnt lgkmcnt(0)
  s_add_u32 s8, s38, s40
  s_addc_u32 s9, s39, 0
  s_mov_b32 s10, 221184
  s_mov_b32 s11, 0x00020000
  s_add_u32 s12, s38, s41
  s_addc_u32 s13, s39, 0
  s_mov_b32 s14, 276480
  s_mov_b32 s15, 0x00020000
  s_add_u32 s16, s38, 2686976
  s_addc_u32 s17, s39, 0
  s_mov_b32 s18, 2621440
  s_mov_b32 s19, 0x00020000
  s_mov_b32 s20, s4
  s_mov_b32 s21, s5
  s_mov_b32 s22, 2621440
  s_mov_b32 s23, 0x00020000
  v_add_u32 v3, 0, v2
  s_movk_i32 s41, 6554
  v_mul_u32_u24 v4, s41, v3
  v_lshrrev_b32 v4, 16, v4
  v_mul_u32_u24 v6, 10, v4
  v_sub_u32 v5, v3, v6
  s_lshl_b32 s40, s24, 6
  v_add_u32 v4, s40, v4
  s_movk_i32 s41, 1280
  v_mul_lo_u32 v10, v4, s41
  v_lshl_add_u32 v10, v5, 4, v10
  s_mul_i32 s40, s25, 160
  v_add_u32 v10, s40, v10
  v_cmp_gt_u32 vcc, 640, v3
  v_cndmask_b32 v10, -1, v10, vcc
  buffer_load_dwordx4 v[12:15], v10, s[16:19], 0 offen
  s_cmp_ge_u32 s26, 4
  s_cbranch_scc1 L4_loader
  s_mul_i32 s34, s26, 36864
  v_and_b32 v3, 15, v0
  v_lshrrev_b32 v4, 4, v0
  v_lshrrev_b32 v5, 2, v3
  v_sub_u32 v6, 0, v5
  v_xor_b32 v6, v6, v4
  v_and_b32 v6, 3, v6
  v_lshlrev_b32 v6, 4, v6
  v_lshl_add_u32 v6, v3, 6, v6
  v_add_u32 v8, s34, v6
  v_lshrrev_b32 v6, 1, v4
  v_lshl_add_u32 v6, v6, 4, v5
  v_and_b32 v4, 1, v4
  v_lshl_add_u32 v6, v4, 2, v6
  v_mul_u32_u24 v6, 160, v6
  v_and_b32 v3, 3, v3
  v_lshl_add_u32 v6, v3, 3, v6
  v_add_u32 v6, 4096, v6
  v_add_u32 v9, s34, v6
  v_mov_b32 v16, 0
  v_mov_b32 v17, 0
  v_mov_b32 v18, 0
  v_mov_b32 v19, 0
  v_mov_b32 v20, 0
  v_mov_b32 v21, 0
  v_mov_b32 v22, 0
  v_mov_b32 v23, 0
  v_mov_b32 v24, 0
  v_mov_b32 v25, 0
  v_mov_b32 v26, 0
  v_mov_b32 v27, 0
  v_mov_b32 v28, 0
  v_mov_b32 v29, 0
  v_mov_b32 v30, 0
  v_mov_b32 v31, 0
  v_mov_b32 v32, 0
  v_mov_b32 v33, 0
  v_mov_b32 v34, 0
  v_mov_b32 v35, 0
  v_mov_b32 v36, 0
  v_mov_b32 v37, 0
  v_mov_b32 v38, 0
  v_mov_b32 v39, 0
  v_mov_b32 v40, 0
  v_mov_b32 v41, 0
  v_mov_b32 v42, 0
  v_mov_b32 v43, 0
  v_mov_b32 v44, 0
  v_mov_b32 v45, 0
  v_mov_b32 v46, 0
  v_mov_b32 v47, 0
  v_mov_b32 v48, 0
  v_mov_b32 v49, 0
  v_mov_b32 v50, 0
  v_mov_b32 v51, 0
  v_mov_b32 v52, 0
  v_mov_b32 v53, 0
  v_mov_b32 v54, 0
  v_mov_b32 v55, 0
  v_mov_b32 v56, 0
  v_mov_b32 v57, 0
  v_mov_b32 v58, 0
  v_mov_b32 v59, 0
  v_mov_b32 v60, 0
  v_mov_b32 v61, 0
  v_mov_b32 v62, 0
  v_mov_b32 v63, 0
  v_mov_b32 v64, 0
  v_mov_b32 v65, 0
  v_mov_b32 v66, 0
  v_mov_b32 v67, 0
  v_mov_b32 v68, 0
  v_mov_b32 v69, 0
  v_mov_b32 v70, 0
  v_mov_b32 v71, 0
  v_mov_b32 v72, 0
  v_mov_b32 v73, 0
  v_mov_b32 v74, 0
  v_mov_b32 v75, 0
  v_mov_b32 v76, 0
  v_mov_b32 v77, 0
  v_mov_b32 v78, 0
  v_mov_b32 v79, 0
  v_mov_b32 v80, 0
  v_mov_b32 v81, 0
  v_mov_b32 v82, 0
  v_mov_b32 v83, 0
  v_mov_b32 v84, 0
  v_mov_b32 v85, 0
  v_mov_b32 v86, 0
  v_mov_b32 v87, 0
  v_mov_b32 v88, 0
  v_mov_b32 v89, 0
  v_mov_b32 v90, 0
  v_mov_b32 v91, 0
  v_mov_b32 v92, 0
  v_mov_b32 v93, 0
  v_mov_b32 v94, 0
  v_mov_b32 v95, 0
  s_barrier
  ds_read_b128 v[96:99], v8 offset:0
  ds_read_b128 v[100:103], v8 offset:1024
  ds_read_b128 v[104:107], v8 offset:2048
  ds_read_b128 v[108:111], v8 offset:3072
  ds_read_b64_tr_b16 v[112:113], v9 offset:0
  ds_read_b64_tr_b16 v[114:115], v9 offset:1280
  ds_read_b64_tr_b16 v[116:117], v9 offset:32
  ds_read_b64_tr_b16 v[118:119], v9 offset:1312
  ds_read_b64_tr_b16 v[120:121], v9 offset:64
  ds_read_b64_tr_b16 v[122:123], v9 offset:1344
  ds_read_b64_tr_b16 v[124:125], v9 offset:96
  ds_read_b64_tr_b16 v[126:127], v9 offset:1376
  ds_read_b64_tr_b16 v[128:129], v9 offset:128
  ds_read_b64_tr_b16 v[130:131], v9 offset:1408
  s_waitcnt lgkmcnt(0)
  s_barrier
  v_mfma_f32_16x16x32_bf16 v[16:19], v[112:115], v[96:99], v[16:19]
  ds_read_b128 v[132:135], v8 offset:9216
  v_mfma_f32_16x16x32_bf16 v[20:23], v[116:119], v[96:99], v[20:23]
  ds_read_b128 v[136:139], v8 offset:10240
  v_mfma_f32_16x16x32_bf16 v[24:27], v[120:123], v[96:99], v[24:27]
  ds_read_b128 v[140:143], v8 offset:11264
  v_mfma_f32_16x16x32_bf16 v[28:31], v[124:127], v[96:99], v[28:31]
  ds_read_b128 v[144:147], v8 offset:12288
  v_mfma_f32_16x16x32_bf16 v[32:35], v[128:131], v[96:99], v[32:35]
  ds_read_b64_tr_b16 v[148:149], v9 offset:9216
  v_mfma_f32_16x16x32_bf16 v[36:39], v[112:115], v[100:103], v[36:39]
  ds_read_b64_tr_b16 v[150:151], v9 offset:10496
  v_mfma_f32_16x16x32_bf16 v[40:43], v[116:119], v[100:103], v[40:43]
  ds_read_b64_tr_b16 v[152:153], v9 offset:9248
  v_mfma_f32_16x16x32_bf16 v[44:47], v[120:123], v[100:103], v[44:47]
  ds_read_b64_tr_b16 v[154:155], v9 offset:10528
  v_mfma_f32_16x16x32_bf16 v[48:51], v[124:127], v[100:103], v[48:51]
  ds_read_b64_tr_b16 v[156:157], v9 offset:9280
  v_mfma_f32_16x16x32_bf16 v[52:55], v[128:131], v[100:103], v[52:55]
  ds_read_b64_tr_b16 v[158:159], v9 offset:10560
  v_mfma_f32_16x16x32_bf16 v[56:59], v[112:115], v[104:107], v[56:59]
  ds_read_b64_tr_b16 v[160:161], v9 offset:9312
  v_mfma_f32_16x16x32_bf16 v[60:63], v[116:119], v[104:107], v[60:63]
  ds_read_b64_tr_b16 v[162:163], v9 offset:10592
  v_mfma_f32_16x16x32_bf16 v[64:67], v[120:123], v[104:107], v[64:67]
  ds_read_b64_tr_b16 v[164:165], v9 offset:9344
  v_mfma_f32_16x16x32_bf16 v[68:71], v[124:127], v[104:107], v[68:71]
  ds_read_b64_tr_b16 v[166:167], v9 offset:10624
  v_mfma_f32_16x16x32_bf16 v[72:75], v[128:131], v[104:107], v[72:75]
  v_mfma_f32_16x16x32_bf16 v[76:79], v[112:115], v[108:111], v[76:79]
  v_mfma_f32_16x16x32_bf16 v[80:83], v[116:119], v[108:111], v[80:83]
  v_mfma_f32_16x16x32_bf16 v[84:87], v[120:123], v[108:111], v[84:87]
  v_mfma_f32_16x16x32_bf16 v[88:91], v[124:127], v[108:111], v[88:91]
  v_mfma_f32_16x16x32_bf16 v[92:95], v[128:131], v[108:111], v[92:95]
  s_waitcnt lgkmcnt(0)
  s_barrier
  v_mfma_f32_16x16x32_bf16 v[16:19], v[148:151], v[132:135], v[16:19]
  ds_read_b128 v[96:99], v8 offset:18432
  v_mfma_f32_16x16x32_bf16 v[20:23], v[152:155], v[132:135], v[20:23]
  ds_read_b128 v[100:103], v8 offset:19456
  v_mfma_f32_16x16x32_bf16 v[24:27], v[156:159], v[132:135], v[24:27]
  ds_read_b128 v[104:107], v8 offset:20480
  v_mfma_f32_16x16x32_bf16 v[28:31], v[160:163], v[132:135], v[28:31]
  ds_read_b128 v[108:111], v8 offset:21504
  v_mfma_f32_16x16x32_bf16 v[32:35], v[164:167], v[132:135], v[32:35]
  ds_read_b64_tr_b16 v[112:113], v9 offset:18432
  v_mfma_f32_16x16x32_bf16 v[36:39], v[148:151], v[136:139], v[36:39]
  ds_read_b64_tr_b16 v[114:115], v9 offset:19712
  v_mfma_f32_16x16x32_bf16 v[40:43], v[152:155], v[136:139], v[40:43]
  ds_read_b64_tr_b16 v[116:117], v9 offset:18464
  v_mfma_f32_16x16x32_bf16 v[44:47], v[156:159], v[136:139], v[44:47]
  ds_read_b64_tr_b16 v[118:119], v9 offset:19744
  v_mfma_f32_16x16x32_bf16 v[48:51], v[160:163], v[136:139], v[48:51]
  ds_read_b64_tr_b16 v[120:121], v9 offset:18496
  v_mfma_f32_16x16x32_bf16 v[52:55], v[164:167], v[136:139], v[52:55]
  ds_read_b64_tr_b16 v[122:123], v9 offset:19776
  v_mfma_f32_16x16x32_bf16 v[56:59], v[148:151], v[140:143], v[56:59]
  ds_read_b64_tr_b16 v[124:125], v9 offset:18528
  v_mfma_f32_16x16x32_bf16 v[60:63], v[152:155], v[140:143], v[60:63]
  ds_read_b64_tr_b16 v[126:127], v9 offset:19808
  v_mfma_f32_16x16x32_bf16 v[64:67], v[156:159], v[140:143], v[64:67]
  ds_read_b64_tr_b16 v[128:129], v9 offset:18560
  v_mfma_f32_16x16x32_bf16 v[68:71], v[160:163], v[140:143], v[68:71]
  ds_read_b64_tr_b16 v[130:131], v9 offset:19840
  v_mfma_f32_16x16x32_bf16 v[72:75], v[164:167], v[140:143], v[72:75]
  v_mfma_f32_16x16x32_bf16 v[76:79], v[148:151], v[144:147], v[76:79]
  v_mfma_f32_16x16x32_bf16 v[80:83], v[152:155], v[144:147], v[80:83]
  v_mfma_f32_16x16x32_bf16 v[84:87], v[156:159], v[144:147], v[84:87]
  v_mfma_f32_16x16x32_bf16 v[88:91], v[160:163], v[144:147], v[88:91]
  v_mfma_f32_16x16x32_bf16 v[92:95], v[164:167], v[144:147], v[92:95]
  s_waitcnt lgkmcnt(0)
  s_barrier
  v_mfma_f32_16x16x32_bf16 v[16:19], v[112:115], v[96:99], v[16:19]
  ds_read_b128 v[132:135], v8 offset:27648
  v_mfma_f32_16x16x32_bf16 v[20:23], v[116:119], v[96:99], v[20:23]
  ds_read_b128 v[136:139], v8 offset:28672
  v_mfma_f32_16x16x32_bf16 v[24:27], v[120:123], v[96:99], v[24:27]
  ds_read_b128 v[140:143], v8 offset:29696
  v_mfma_f32_16x16x32_bf16 v[28:31], v[124:127], v[96:99], v[28:31]
  ds_read_b128 v[144:147], v8 offset:30720
  v_mfma_f32_16x16x32_bf16 v[32:35], v[128:131], v[96:99], v[32:35]
  ds_read_b64_tr_b16 v[148:149], v9 offset:27648
  v_mfma_f32_16x16x32_bf16 v[36:39], v[112:115], v[100:103], v[36:39]
  ds_read_b64_tr_b16 v[150:151], v9 offset:28928
  v_mfma_f32_16x16x32_bf16 v[40:43], v[116:119], v[100:103], v[40:43]
  ds_read_b64_tr_b16 v[152:153], v9 offset:27680
  v_mfma_f32_16x16x32_bf16 v[44:47], v[120:123], v[100:103], v[44:47]
  ds_read_b64_tr_b16 v[154:155], v9 offset:28960
  v_mfma_f32_16x16x32_bf16 v[48:51], v[124:127], v[100:103], v[48:51]
  ds_read_b64_tr_b16 v[156:157], v9 offset:27712
  v_mfma_f32_16x16x32_bf16 v[52:55], v[128:131], v[100:103], v[52:55]
  ds_read_b64_tr_b16 v[158:159], v9 offset:28992
  v_mfma_f32_16x16x32_bf16 v[56:59], v[112:115], v[104:107], v[56:59]
  ds_read_b64_tr_b16 v[160:161], v9 offset:27744
  v_mfma_f32_16x16x32_bf16 v[60:63], v[116:119], v[104:107], v[60:63]
  ds_read_b64_tr_b16 v[162:163], v9 offset:29024
  v_mfma_f32_16x16x32_bf16 v[64:67], v[120:123], v[104:107], v[64:67]
  ds_read_b64_tr_b16 v[164:165], v9 offset:27776
  v_mfma_f32_16x16x32_bf16 v[68:71], v[124:127], v[104:107], v[68:71]
  ds_read_b64_tr_b16 v[166:167], v9 offset:29056
  v_mfma_f32_16x16x32_bf16 v[72:75], v[128:131], v[104:107], v[72:75]
  v_mfma_f32_16x16x32_bf16 v[76:79], v[112:115], v[108:111], v[76:79]
  v_mfma_f32_16x16x32_bf16 v[80:83], v[116:119], v[108:111], v[80:83]
  v_mfma_f32_16x16x32_bf16 v[84:87], v[120:123], v[108:111], v[84:87]
  v_mfma_f32_16x16x32_bf16 v[88:91], v[124:127], v[108:111], v[88:91]
  v_mfma_f32_16x16x32_bf16 v[92:95], v[128:131], v[108:111], v[92:95]
  s_waitcnt lgkmcnt(0)
  s_barrier
  v_mfma_f32_16x16x32_bf16 v[16:19], v[148:151], v[132:135], v[16:19]
  ds_read_b128 v[96:99], v8 offset:0
  v_mfma_f32_16x16x32_bf16 v[20:23], v[152:155], v[132:135], v[20:23]
  ds_read_b128 v[100:103], v8 offset:1024
  v_mfma_f32_16x16x32_bf16 v[24:27], v[156:159], v[132:135], v[24:27]
  ds_read_b128 v[104:107], v8 offset:2048
  v_mfma_f32_16x16x32_bf16 v[28:31], v[160:163], v[132:135], v[28:31]
  ds_read_b128 v[108:111], v8 offset:3072
  v_mfma_f32_16x16x32_bf16 v[32:35], v[164:167], v[132:135], v[32:35]
  ds_read_b64_tr_b16 v[112:113], v9 offset:0
  v_mfma_f32_16x16x32_bf16 v[36:39], v[148:151], v[136:139], v[36:39]
  ds_read_b64_tr_b16 v[114:115], v9 offset:1280
  v_mfma_f32_16x16x32_bf16 v[40:43], v[152:155], v[136:139], v[40:43]
  ds_read_b64_tr_b16 v[116:117], v9 offset:32
  v_mfma_f32_16x16x32_bf16 v[44:47], v[156:159], v[136:139], v[44:47]
  ds_read_b64_tr_b16 v[118:119], v9 offset:1312
  v_mfma_f32_16x16x32_bf16 v[48:51], v[160:163], v[136:139], v[48:51]
  ds_read_b64_tr_b16 v[120:121], v9 offset:64
  v_mfma_f32_16x16x32_bf16 v[52:55], v[164:167], v[136:139], v[52:55]
  ds_read_b64_tr_b16 v[122:123], v9 offset:1344
  v_mfma_f32_16x16x32_bf16 v[56:59], v[148:151], v[140:143], v[56:59]
  ds_read_b64_tr_b16 v[124:125], v9 offset:96
  v_mfma_f32_16x16x32_bf16 v[60:63], v[152:155], v[140:143], v[60:63]
  ds_read_b64_tr_b16 v[126:127], v9 offset:1376
  v_mfma_f32_16x16x32_bf16 v[64:67], v[156:159], v[140:143], v[64:67]
  ds_read_b64_tr_b16 v[128:129], v9 offset:128
  v_mfma_f32_16x16x32_bf16 v[68:71], v[160:163], v[140:143], v[68:71]
  ds_read_b64_tr_b16 v[130:131], v9 offset:1408
  v_mfma_f32_16x16x32_bf16 v[72:75], v[164:167], v[140:143], v[72:75]
  v_mfma_f32_16x16x32_bf16 v[76:79], v[148:151], v[144:147], v[76:79]
  v_mfma_f32_16x16x32_bf16 v[80:83], v[152:155], v[144:147], v[80:83]
  v_mfma_f32_16x16x32_bf16 v[84:87], v[156:159], v[144:147], v[84:87]
  v_mfma_f32_16x16x32_bf16 v[88:91], v[160:163], v[144:147], v[88:91]
  v_mfma_f32_16x16x32_bf16 v[92:95], v[164:167], v[144:147], v[92:95]
  s_waitcnt lgkmcnt(0)
  s_barrier
  v_mfma_f32_16x16x32_bf16 v[16:19], v[112:115], v[96:99], v[16:19]
  ds_read_b128 v[132:135], v8 offset:9216
  v_mfma_f32_16x16x32_bf16 v[20:23], v[116:119], v[96:99], v[20:23]
  ds_read_b128 v[136:139], v8 offset:10240
  v_mfma_f32_16x16x32_bf16 v[24:27], v[120:123], v[96:99], v[24:27]
  ds_read_b128 v[140:143], v8 offset:11264
  v_mfma_f32_16x16x32_bf16 v[28:31], v[124:127], v[96:99], v[28:31]
  ds_read_b128 v[144:147], v8 offset:12288
  v_mfma_f32_16x16x32_bf16 v[32:35], v[128:131], v[96:99], v[32:35]
  ds_read_b64_tr_b16 v[148:149], v9 offset:9216
  v_mfma_f32_16x16x32_bf16 v[36:39], v[112:115], v[100:103], v[36:39]
  ds_read_b64_tr_b16 v[150:151], v9 offset:10496
  v_mfma_f32_16x16x32_bf16 v[40:43], v[116:119], v[100:103], v[40:43]
  ds_read_b64_tr_b16 v[152:153], v9 offset:9248
  v_mfma_f32_16x16x32_bf16 v[44:47], v[120:123], v[100:103], v[44:47]
  ds_read_b64_tr_b16 v[154:155], v9 offset:10528
  v_mfma_f32_16x16x32_bf16 v[48:51], v[124:127], v[100:103], v[48:51]
  ds_read_b64_tr_b16 v[156:157], v9 offset:9280
  v_mfma_f32_16x16x32_bf16 v[52:55], v[128:131], v[100:103], v[52:55]
  ds_read_b64_tr_b16 v[158:159], v9 offset:10560
  v_mfma_f32_16x16x32_bf16 v[56:59], v[112:115], v[104:107], v[56:59]
  ds_read_b64_tr_b16 v[160:161], v9 offset:9312
  v_mfma_f32_16x16x32_bf16 v[60:63], v[116:119], v[104:107], v[60:63]
  ds_read_b64_tr_b16 v[162:163], v9 offset:10592
  v_mfma_f32_16x16x32_bf16 v[64:67], v[120:123], v[104:107], v[64:67]
  ds_read_b64_tr_b16 v[164:165], v9 offset:9344
  v_mfma_f32_16x16x32_bf16 v[68:71], v[124:127], v[104:107], v[68:71]
  ds_read_b64_tr_b16 v[166:167], v9 offset:10624
  v_mfma_f32_16x16x32_bf16 v[72:75], v[128:131], v[104:107], v[72:75]
  v_mfma_f32_16x16x32_bf16 v[76:79], v[112:115], v[108:111], v[76:79]
  v_mfma_f32_16x16x32_bf16 v[80:83], v[116:119], v[108:111], v[80:83]
  v_mfma_f32_16x16x32_bf16 v[84:87], v[120:123], v[108:111], v[84:87]
  v_mfma_f32_16x16x32_bf16 v[88:91], v[124:127], v[108:111], v[88:91]
  v_mfma_f32_16x16x32_bf16 v[92:95], v[128:131], v[108:111], v[92:95]
  s_waitcnt lgkmcnt(0)
  s_barrier
  v_mfma_f32_16x16x32_bf16 v[16:19], v[148:151], v[132:135], v[16:19]
  ds_read_b128 v[96:99], v8 offset:18432
  v_mfma_f32_16x16x32_bf16 v[20:23], v[152:155], v[132:135], v[20:23]
  ds_read_b128 v[100:103], v8 offset:19456
  v_mfma_f32_16x16x32_bf16 v[24:27], v[156:159], v[132:135], v[24:27]
  ds_read_b128 v[104:107], v8 offset:20480
  v_mfma_f32_16x16x32_bf16 v[28:31], v[160:163], v[132:135], v[28:31]
  ds_read_b128 v[108:111], v8 offset:21504
  v_mfma_f32_16x16x32_bf16 v[32:35], v[164:167], v[132:135], v[32:35]
  ds_read_b64_tr_b16 v[112:113], v9 offset:18432
  v_mfma_f32_16x16x32_bf16 v[36:39], v[148:151], v[136:139], v[36:39]
  ds_read_b64_tr_b16 v[114:115], v9 offset:19712
  v_mfma_f32_16x16x32_bf16 v[40:43], v[152:155], v[136:139], v[40:43]
  ds_read_b64_tr_b16 v[116:117], v9 offset:18464
  v_mfma_f32_16x16x32_bf16 v[44:47], v[156:159], v[136:139], v[44:47]
  ds_read_b64_tr_b16 v[118:119], v9 offset:19744
  v_mfma_f32_16x16x32_bf16 v[48:51], v[160:163], v[136:139], v[48:51]
  ds_read_b64_tr_b16 v[120:121], v9 offset:18496
  v_mfma_f32_16x16x32_bf16 v[52:55], v[164:167], v[136:139], v[52:55]
  ds_read_b64_tr_b16 v[122:123], v9 offset:19776
  v_mfma_f32_16x16x32_bf16 v[56:59], v[148:151], v[140:143], v[56:59]
  ds_read_b64_tr_b16 v[124:125], v9 offset:18528
  v_mfma_f32_16x16x32_bf16 v[60:63], v[152:155], v[140:143], v[60:63]
  ds_read_b64_tr_b16 v[126:127], v9 offset:19808
  v_mfma_f32_16x16x32_bf16 v[64:67], v[156:159], v[140:143], v[64:67]
  ds_read_b64_tr_b16 v[128:129], v9 offset:18560
  v_mfma_f32_16x16x32_bf16 v[68:71], v[160:163], v[140:143], v[68:71]
  ds_read_b64_tr_b16 v[130:131], v9 offset:19840
  v_mfma_f32_16x16x32_bf16 v[72:75], v[164:167], v[140:143], v[72:75]
  v_mfma_f32_16x16x32_bf16 v[76:79], v[148:151], v[144:147], v[76:79]
  v_mfma_f32_16x16x32_bf16 v[80:83], v[152:155], v[144:147], v[80:83]
  v_mfma_f32_16x16x32_bf16 v[84:87], v[156:159], v[144:147], v[84:87]
  v_mfma_f32_16x16x32_bf16 v[88:91], v[160:163], v[144:147], v[88:91]
  v_mfma_f32_16x16x32_bf16 v[92:95], v[164:167], v[144:147], v[92:95]
  s_waitcnt lgkmcnt(0)
  s_barrier
  v_mfma_f32_16x16x32_bf16 v[16:19], v[112:115], v[96:99], v[16:19]
  ds_read_b128 v[132:135], v8 offset:27648
  v_mfma_f32_16x16x32_bf16 v[20:23], v[116:119], v[96:99], v[20:23]
  ds_read_b128 v[136:139], v8 offset:28672
  v_mfma_f32_16x16x32_bf16 v[24:27], v[120:123], v[96:99], v[24:27]
  ds_read_b128 v[140:143], v8 offset:29696
  v_mfma_f32_16x16x32_bf16 v[28:31], v[124:127], v[96:99], v[28:31]
  ds_read_b128 v[144:147], v8 offset:30720
  v_mfma_f32_16x16x32_bf16 v[32:35], v[128:131], v[96:99], v[32:35]
  ds_read_b64_tr_b16 v[148:149], v9 offset:27648
  v_mfma_f32_16x16x32_bf16 v[36:39], v[112:115], v[100:103], v[36:39]
  ds_read_b64_tr_b16 v[150:151], v9 offset:28928
  v_mfma_f32_16x16x32_bf16 v[40:43], v[116:119], v[100:103], v[40:43]
  ds_read_b64_tr_b16 v[152:153], v9 offset:27680
  v_mfma_f32_16x16x32_bf16 v[44:47], v[120:123], v[100:103], v[44:47]
  ds_read_b64_tr_b16 v[154:155], v9 offset:28960
  v_mfma_f32_16x16x32_bf16 v[48:51], v[124:127], v[100:103], v[48:51]
  ds_read_b64_tr_b16 v[156:157], v9 offset:27712
  v_mfma_f32_16x16x32_bf16 v[52:55], v[128:131], v[100:103], v[52:55]
  ds_read_b64_tr_b16 v[158:159], v9 offset:28992
  v_mfma_f32_16x16x32_bf16 v[56:59], v[112:115], v[104:107], v[56:59]
  ds_read_b64_tr_b16 v[160:161], v9 offset:27744
  v_mfma_f32_16x16x32_bf16 v[60:63], v[116:119], v[104:107], v[60:63]
  ds_read_b64_tr_b16 v[162:163], v9 offset:29024
  v_mfma_f32_16x16x32_bf16 v[64:67], v[120:123], v[104:107], v[64:67]
  ds_read_b64_tr_b16 v[164:165], v9 offset:27776
  v_mfma_f32_16x16x32_bf16 v[68:71], v[124:127], v[104:107], v[68:71]
  ds_read_b64_tr_b16 v[166:167], v9 offset:29056
  v_mfma_f32_16x16x32_bf16 v[72:75], v[128:131], v[104:107], v[72:75]
  v_mfma_f32_16x16x32_bf16 v[76:79], v[112:115], v[108:111], v[76:79]
  v_mfma_f32_16x16x32_bf16 v[80:83], v[116:119], v[108:111], v[80:83]
  v_mfma_f32_16x16x32_bf16 v[84:87], v[120:123], v[108:111], v[84:87]
  v_mfma_f32_16x16x32_bf16 v[88:91], v[124:127], v[108:111], v[88:91]
  v_mfma_f32_16x16x32_bf16 v[92:95], v[128:131], v[108:111], v[92:95]
  s_waitcnt lgkmcnt(0)
  s_barrier
  v_mfma_f32_16x16x32_bf16 v[16:19], v[148:151], v[132:135], v[16:19]
  ds_read_b128 v[96:99], v8 offset:0
  v_mfma_f32_16x16x32_bf16 v[20:23], v[152:155], v[132:135], v[20:23]
  ds_read_b128 v[100:103], v8 offset:1024
  v_mfma_f32_16x16x32_bf16 v[24:27], v[156:159], v[132:135], v[24:27]
  ds_read_b128 v[104:107], v8 offset:2048
  v_mfma_f32_16x16x32_bf16 v[28:31], v[160:163], v[132:135], v[28:31]
  ds_read_b128 v[108:111], v8 offset:3072
  v_mfma_f32_16x16x32_bf16 v[32:35], v[164:167], v[132:135], v[32:35]
  ds_read_b64_tr_b16 v[112:113], v9 offset:0
  v_mfma_f32_16x16x32_bf16 v[36:39], v[148:151], v[136:139], v[36:39]
  ds_read_b64_tr_b16 v[114:115], v9 offset:1280
  v_mfma_f32_16x16x32_bf16 v[40:43], v[152:155], v[136:139], v[40:43]
  ds_read_b64_tr_b16 v[116:117], v9 offset:32
  v_mfma_f32_16x16x32_bf16 v[44:47], v[156:159], v[136:139], v[44:47]
  ds_read_b64_tr_b16 v[118:119], v9 offset:1312
  v_mfma_f32_16x16x32_bf16 v[48:51], v[160:163], v[136:139], v[48:51]
  ds_read_b64_tr_b16 v[120:121], v9 offset:64
  v_mfma_f32_16x16x32_bf16 v[52:55], v[164:167], v[136:139], v[52:55]
  ds_read_b64_tr_b16 v[122:123], v9 offset:1344
  v_mfma_f32_16x16x32_bf16 v[56:59], v[148:151], v[140:143], v[56:59]
  ds_read_b64_tr_b16 v[124:125], v9 offset:96
  v_mfma_f32_16x16x32_bf16 v[60:63], v[152:155], v[140:143], v[60:63]
  ds_read_b64_tr_b16 v[126:127], v9 offset:1376
  v_mfma_f32_16x16x32_bf16 v[64:67], v[156:159], v[140:143], v[64:67]
  ds_read_b64_tr_b16 v[128:129], v9 offset:128
  v_mfma_f32_16x16x32_bf16 v[68:71], v[160:163], v[140:143], v[68:71]
  ds_read_b64_tr_b16 v[130:131], v9 offset:1408
  v_mfma_f32_16x16x32_bf16 v[72:75], v[164:167], v[140:143], v[72:75]
  v_mfma_f32_16x16x32_bf16 v[76:79], v[148:151], v[144:147], v[76:79]
  v_mfma_f32_16x16x32_bf16 v[80:83], v[152:155], v[144:147], v[80:83]
  v_mfma_f32_16x16x32_bf16 v[84:87], v[156:159], v[144:147], v[84:87]
  v_mfma_f32_16x16x32_bf16 v[88:91], v[160:163], v[144:147], v[88:91]
  v_mfma_f32_16x16x32_bf16 v[92:95], v[164:167], v[144:147], v[92:95]
  s_waitcnt lgkmcnt(0)
  s_barrier
  v_mfma_f32_16x16x32_bf16 v[16:19], v[112:115], v[96:99], v[16:19]
  ds_read_b128 v[132:135], v8 offset:9216
  v_mfma_f32_16x16x32_bf16 v[20:23], v[116:119], v[96:99], v[20:23]
  ds_read_b128 v[136:139], v8 offset:10240
  v_mfma_f32_16x16x32_bf16 v[24:27], v[120:123], v[96:99], v[24:27]
  ds_read_b128 v[140:143], v8 offset:11264
  v_mfma_f32_16x16x32_bf16 v[28:31], v[124:127], v[96:99], v[28:31]
  ds_read_b128 v[144:147], v8 offset:12288
  v_mfma_f32_16x16x32_bf16 v[32:35], v[128:131], v[96:99], v[32:35]
  ds_read_b64_tr_b16 v[148:149], v9 offset:9216
  v_mfma_f32_16x16x32_bf16 v[36:39], v[112:115], v[100:103], v[36:39]
  ds_read_b64_tr_b16 v[150:151], v9 offset:10496
  v_mfma_f32_16x16x32_bf16 v[40:43], v[116:119], v[100:103], v[40:43]
  ds_read_b64_tr_b16 v[152:153], v9 offset:9248
  v_mfma_f32_16x16x32_bf16 v[44:47], v[120:123], v[100:103], v[44:47]
  ds_read_b64_tr_b16 v[154:155], v9 offset:10528
  v_mfma_f32_16x16x32_bf16 v[48:51], v[124:127], v[100:103], v[48:51]
  ds_read_b64_tr_b16 v[156:157], v9 offset:9280
  v_mfma_f32_16x16x32_bf16 v[52:55], v[128:131], v[100:103], v[52:55]
  ds_read_b64_tr_b16 v[158:159], v9 offset:10560
  v_mfma_f32_16x16x32_bf16 v[56:59], v[112:115], v[104:107], v[56:59]
  ds_read_b64_tr_b16 v[160:161], v9 offset:9312
  v_mfma_f32_16x16x32_bf16 v[60:63], v[116:119], v[104:107], v[60:63]
  ds_read_b64_tr_b16 v[162:163], v9 offset:10592
  v_mfma_f32_16x16x32_bf16 v[64:67], v[120:123], v[104:107], v[64:67]
  ds_read_b64_tr_b16 v[164:165], v9 offset:9344
  v_mfma_f32_16x16x32_bf16 v[68:71], v[124:127], v[104:107], v[68:71]
  ds_read_b64_tr_b16 v[166:167], v9 offset:10624
  v_mfma_f32_16x16x32_bf16 v[72:75], v[128:131], v[104:107], v[72:75]
  v_mfma_f32_16x16x32_bf16 v[76:79], v[112:115], v[108:111], v[76:79]
  v_mfma_f32_16x16x32_bf16 v[80:83], v[116:119], v[108:111], v[80:83]
  v_mfma_f32_16x16x32_bf16 v[84:87], v[120:123], v[108:111], v[84:87]
  v_mfma_f32_16x16x32_bf16 v[88:91], v[124:127], v[108:111], v[88:91]
  v_mfma_f32_16x16x32_bf16 v[92:95], v[128:131], v[108:111], v[92:95]
  s_waitcnt lgkmcnt(0)
  s_barrier
  v_mfma_f32_16x16x32_bf16 v[16:19], v[148:151], v[132:135], v[16:19]
  ds_read_b128 v[96:99], v8 offset:18432
  v_mfma_f32_16x16x32_bf16 v[20:23], v[152:155], v[132:135], v[20:23]
  ds_read_b128 v[100:103], v8 offset:19456
  v_mfma_f32_16x16x32_bf16 v[24:27], v[156:159], v[132:135], v[24:27]
  ds_read_b128 v[104:107], v8 offset:20480
  v_mfma_f32_16x16x32_bf16 v[28:31], v[160:163], v[132:135], v[28:31]
  ds_read_b128 v[108:111], v8 offset:21504
  v_mfma_f32_16x16x32_bf16 v[32:35], v[164:167], v[132:135], v[32:35]
  ds_read_b64_tr_b16 v[112:113], v9 offset:18432
  v_mfma_f32_16x16x32_bf16 v[36:39], v[148:151], v[136:139], v[36:39]
  ds_read_b64_tr_b16 v[114:115], v9 offset:19712
  v_mfma_f32_16x16x32_bf16 v[40:43], v[152:155], v[136:139], v[40:43]
  ds_read_b64_tr_b16 v[116:117], v9 offset:18464
  v_mfma_f32_16x16x32_bf16 v[44:47], v[156:159], v[136:139], v[44:47]
  ds_read_b64_tr_b16 v[118:119], v9 offset:19744
  v_mfma_f32_16x16x32_bf16 v[48:51], v[160:163], v[136:139], v[48:51]
  ds_read_b64_tr_b16 v[120:121], v9 offset:18496
  v_mfma_f32_16x16x32_bf16 v[52:55], v[164:167], v[136:139], v[52:55]
  ds_read_b64_tr_b16 v[122:123], v9 offset:19776
  v_mfma_f32_16x16x32_bf16 v[56:59], v[148:151], v[140:143], v[56:59]
  ds_read_b64_tr_b16 v[124:125], v9 offset:18528
  v_mfma_f32_16x16x32_bf16 v[60:63], v[152:155], v[140:143], v[60:63]
  ds_read_b64_tr_b16 v[126:127], v9 offset:19808
  v_mfma_f32_16x16x32_bf16 v[64:67], v[156:159], v[140:143], v[64:67]
  ds_read_b64_tr_b16 v[128:129], v9 offset:18560
  v_mfma_f32_16x16x32_bf16 v[68:71], v[160:163], v[140:143], v[68:71]
  ds_read_b64_tr_b16 v[130:131], v9 offset:19840
  v_mfma_f32_16x16x32_bf16 v[72:75], v[164:167], v[140:143], v[72:75]
  v_mfma_f32_16x16x32_bf16 v[76:79], v[148:151], v[144:147], v[76:79]
  v_mfma_f32_16x16x32_bf16 v[80:83], v[152:155], v[144:147], v[80:83]
  v_mfma_f32_16x16x32_bf16 v[84:87], v[156:159], v[144:147], v[84:87]
  v_mfma_f32_16x16x32_bf16 v[88:91], v[160:163], v[144:147], v[88:91]
  v_mfma_f32_16x16x32_bf16 v[92:95], v[164:167], v[144:147], v[92:95]
  s_waitcnt lgkmcnt(0)
  s_barrier
  v_mfma_f32_16x16x32_bf16 v[16:19], v[112:115], v[96:99], v[16:19]
  ds_read_b128 v[132:135], v8 offset:27648
  v_mfma_f32_16x16x32_bf16 v[20:23], v[116:119], v[96:99], v[20:23]
  ds_read_b128 v[136:139], v8 offset:28672
  v_mfma_f32_16x16x32_bf16 v[24:27], v[120:123], v[96:99], v[24:27]
  ds_read_b128 v[140:143], v8 offset:29696
  v_mfma_f32_16x16x32_bf16 v[28:31], v[124:127], v[96:99], v[28:31]
  ds_read_b128 v[144:147], v8 offset:30720
  v_mfma_f32_16x16x32_bf16 v[32:35], v[128:131], v[96:99], v[32:35]
  ds_read_b64_tr_b16 v[148:149], v9 offset:27648
  v_mfma_f32_16x16x32_bf16 v[36:39], v[112:115], v[100:103], v[36:39]
  ds_read_b64_tr_b16 v[150:151], v9 offset:28928
  v_mfma_f32_16x16x32_bf16 v[40:43], v[116:119], v[100:103], v[40:43]
  ds_read_b64_tr_b16 v[152:153], v9 offset:27680
  v_mfma_f32_16x16x32_bf16 v[44:47], v[120:123], v[100:103], v[44:47]
  ds_read_b64_tr_b16 v[154:155], v9 offset:28960
  v_mfma_f32_16x16x32_bf16 v[48:51], v[124:127], v[100:103], v[48:51]
  ds_read_b64_tr_b16 v[156:157], v9 offset:27712
  v_mfma_f32_16x16x32_bf16 v[52:55], v[128:131], v[100:103], v[52:55]
  ds_read_b64_tr_b16 v[158:159], v9 offset:28992
  v_mfma_f32_16x16x32_bf16 v[56:59], v[112:115], v[104:107], v[56:59]
  ds_read_b64_tr_b16 v[160:161], v9 offset:27744
  v_mfma_f32_16x16x32_bf16 v[60:63], v[116:119], v[104:107], v[60:63]
  ds_read_b64_tr_b16 v[162:163], v9 offset:29024
  v_mfma_f32_16x16x32_bf16 v[64:67], v[120:123], v[104:107], v[64:67]
  ds_read_b64_tr_b16 v[164:165], v9 offset:27776
  v_mfma_f32_16x16x32_bf16 v[68:71], v[124:127], v[104:107], v[68:71]
  ds_read_b64_tr_b16 v[166:167], v9 offset:29056
  v_mfma_f32_16x16x32_bf16 v[72:75], v[128:131], v[104:107], v[72:75]
  v_mfma_f32_16x16x32_bf16 v[76:79], v[112:115], v[108:111], v[76:79]
  v_mfma_f32_16x16x32_bf16 v[80:83], v[116:119], v[108:111], v[80:83]
  v_mfma_f32_16x16x32_bf16 v[84:87], v[120:123], v[108:111], v[84:87]
  v_mfma_f32_16x16x32_bf16 v[88:91], v[124:127], v[108:111], v[88:91]
  v_mfma_f32_16x16x32_bf16 v[92:95], v[128:131], v[108:111], v[92:95]
  s_waitcnt lgkmcnt(0)
  s_barrier
  v_mfma_f32_16x16x32_bf16 v[16:19], v[148:151], v[132:135], v[16:19]
  ds_read_b128 v[96:99], v8 offset:0
  v_mfma_f32_16x16x32_bf16 v[20:23], v[152:155], v[132:135], v[20:23]
  ds_read_b128 v[100:103], v8 offset:1024
  v_mfma_f32_16x16x32_bf16 v[24:27], v[156:159], v[132:135], v[24:27]
  ds_read_b128 v[104:107], v8 offset:2048
  v_mfma_f32_16x16x32_bf16 v[28:31], v[160:163], v[132:135], v[28:31]
  ds_read_b128 v[108:111], v8 offset:3072
  v_mfma_f32_16x16x32_bf16 v[32:35], v[164:167], v[132:135], v[32:35]
  ds_read_b64_tr_b16 v[112:113], v9 offset:0
  v_mfma_f32_16x16x32_bf16 v[36:39], v[148:151], v[136:139], v[36:39]
  ds_read_b64_tr_b16 v[114:115], v9 offset:1280
  v_mfma_f32_16x16x32_bf16 v[40:43], v[152:155], v[136:139], v[40:43]
  ds_read_b64_tr_b16 v[116:117], v9 offset:32
  v_mfma_f32_16x16x32_bf16 v[44:47], v[156:159], v[136:139], v[44:47]
  ds_read_b64_tr_b16 v[118:119], v9 offset:1312
  v_mfma_f32_16x16x32_bf16 v[48:51], v[160:163], v[136:139], v[48:51]
  ds_read_b64_tr_b16 v[120:121], v9 offset:64
  v_mfma_f32_16x16x32_bf16 v[52:55], v[164:167], v[136:139], v[52:55]
  ds_read_b64_tr_b16 v[122:123], v9 offset:1344
  v_mfma_f32_16x16x32_bf16 v[56:59], v[148:151], v[140:143], v[56:59]
  ds_read_b64_tr_b16 v[124:125], v9 offset:96
  v_mfma_f32_16x16x32_bf16 v[60:63], v[152:155], v[140:143], v[60:63]
  ds_read_b64_tr_b16 v[126:127], v9 offset:1376
  v_mfma_f32_16x16x32_bf16 v[64:67], v[156:159], v[140:143], v[64:67]
  ds_read_b64_tr_b16 v[128:129], v9 offset:128
  v_mfma_f32_16x16x32_bf16 v[68:71], v[160:163], v[140:143], v[68:71]
  ds_read_b64_tr_b16 v[130:131], v9 offset:1408
  v_mfma_f32_16x16x32_bf16 v[72:75], v[164:167], v[140:143], v[72:75]
  v_mfma_f32_16x16x32_bf16 v[76:79], v[148:151], v[144:147], v[76:79]
  v_mfma_f32_16x16x32_bf16 v[80:83], v[152:155], v[144:147], v[80:83]
  v_mfma_f32_16x16x32_bf16 v[84:87], v[156:159], v[144:147], v[84:87]
  v_mfma_f32_16x16x32_bf16 v[88:91], v[160:163], v[144:147], v[88:91]
  v_mfma_f32_16x16x32_bf16 v[92:95], v[164:167], v[144:147], v[92:95]
  s_waitcnt lgkmcnt(0)
  s_barrier
  v_mfma_f32_16x16x32_bf16 v[16:19], v[112:115], v[96:99], v[16:19]
  ds_read_b128 v[132:135], v8 offset:9216
  v_mfma_f32_16x16x32_bf16 v[20:23], v[116:119], v[96:99], v[20:23]
  ds_read_b128 v[136:139], v8 offset:10240
  v_mfma_f32_16x16x32_bf16 v[24:27], v[120:123], v[96:99], v[24:27]
  ds_read_b128 v[140:143], v8 offset:11264
  v_mfma_f32_16x16x32_bf16 v[28:31], v[124:127], v[96:99], v[28:31]
  ds_read_b128 v[144:147], v8 offset:12288
  v_mfma_f32_16x16x32_bf16 v[32:35], v[128:131], v[96:99], v[32:35]
  ds_read_b64_tr_b16 v[148:149], v9 offset:9216
  v_mfma_f32_16x16x32_bf16 v[36:39], v[112:115], v[100:103], v[36:39]
  ds_read_b64_tr_b16 v[150:151], v9 offset:10496
  v_mfma_f32_16x16x32_bf16 v[40:43], v[116:119], v[100:103], v[40:43]
  ds_read_b64_tr_b16 v[152:153], v9 offset:9248
  v_mfma_f32_16x16x32_bf16 v[44:47], v[120:123], v[100:103], v[44:47]
  ds_read_b64_tr_b16 v[154:155], v9 offset:10528
  v_mfma_f32_16x16x32_bf16 v[48:51], v[124:127], v[100:103], v[48:51]
  ds_read_b64_tr_b16 v[156:157], v9 offset:9280
  v_mfma_f32_16x16x32_bf16 v[52:55], v[128:131], v[100:103], v[52:55]
  ds_read_b64_tr_b16 v[158:159], v9 offset:10560
  v_mfma_f32_16x16x32_bf16 v[56:59], v[112:115], v[104:107], v[56:59]
  ds_read_b64_tr_b16 v[160:161], v9 offset:9312
  v_mfma_f32_16x16x32_bf16 v[60:63], v[116:119], v[104:107], v[60:63]
  ds_read_b64_tr_b16 v[162:163], v9 offset:10592
  v_mfma_f32_16x16x32_bf16 v[64:67], v[120:123], v[104:107], v[64:67]
  ds_read_b64_tr_b16 v[164:165], v9 offset:9344
  v_mfma_f32_16x16x32_bf16 v[68:71], v[124:127], v[104:107], v[68:71]
  ds_read_b64_tr_b16 v[166:167], v9 offset:10624
  v_mfma_f32_16x16x32_bf16 v[72:75], v[128:131], v[104:107], v[72:75]
  v_mfma_f32_16x16x32_bf16 v[76:79], v[112:115], v[108:111], v[76:79]
  v_mfma_f32_16x16x32_bf16 v[80:83], v[116:119], v[108:111], v[80:83]
  v_mfma_f32_16x16x32_bf16 v[84:87], v[120:123], v[108:111], v[84:87]
  v_mfma_f32_16x16x32_bf16 v[88:91], v[124:127], v[108:111], v[88:91]
  v_mfma_f32_16x16x32_bf16 v[92:95], v[128:131], v[108:111], v[92:95]
  s_waitcnt lgkmcnt(0)
  v_mfma_f32_16x16x32_bf16 v[16:19], v[148:151], v[132:135], v[16:19]
  v_mfma_f32_16x16x32_bf16 v[20:23], v[152:155], v[132:135], v[20:23]
  v_mfma_f32_16x16x32_bf16 v[24:27], v[156:159], v[132:135], v[24:27]
  v_mfma_f32_16x16x32_bf16 v[28:31], v[160:163], v[132:135], v[28:31]
  v_mfma_f32_16x16x32_bf16 v[32:35], v[164:167], v[132:135], v[32:35]
  v_mfma_f32_16x16x32_bf16 v[36:39], v[148:151], v[136:139], v[36:39]
  v_mfma_f32_16x16x32_bf16 v[40:43], v[152:155], v[136:139], v[40:43]
  v_mfma_f32_16x16x32_bf16 v[44:47], v[156:159], v[136:139], v[44:47]
  v_mfma_f32_16x16x32_bf16 v[48:51], v[160:163], v[136:139], v[48:51]
  v_mfma_f32_16x16x32_bf16 v[52:55], v[164:167], v[136:139], v[52:55]
  v_mfma_f32_16x16x32_bf16 v[56:59], v[148:151], v[140:143], v[56:59]
  v_mfma_f32_16x16x32_bf16 v[60:63], v[152:155], v[140:143], v[60:63]
  v_mfma_f32_16x16x32_bf16 v[64:67], v[156:159], v[140:143], v[64:67]
  v_mfma_f32_16x16x32_bf16 v[68:71], v[160:163], v[140:143], v[68:71]
  v_mfma_f32_16x16x32_bf16 v[72:75], v[164:167], v[140:143], v[72:75]
  v_mfma_f32_16x16x32_bf16 v[76:79], v[148:151], v[144:147], v[76:79]
  v_mfma_f32_16x16x32_bf16 v[80:83], v[152:155], v[144:147], v[80:83]
  v_mfma_f32_16x16x32_bf16 v[84:87], v[156:159], v[144:147], v[84:87]
  v_mfma_f32_16x16x32_bf16 v[88:91], v[160:163], v[144:147], v[88:91]
  v_mfma_f32_16x16x32_bf16 v[92:95], v[164:167], v[144:147], v[92:95]
  v_and_b32 v3, 15, v0
  v_lshrrev_b32 v4, 4, v0
  v_mul_u32_u24 v5, 336, v3
  v_lshl_add_u32 v5, v4, 4, v5
  v_add_u32 v5, s34, v5
  s_nop 7
  ds_write_b128 v5, v[16:19] offset:0
  ds_write_b128 v5, v[20:23] offset:64
  ds_write_b128 v5, v[24:27] offset:128
  ds_write_b128 v5, v[28:31] offset:192
  ds_write_b128 v5, v[32:35] offset:256
  ds_write_b128 v5, v[36:39] offset:5376
  ds_write_b128 v5, v[40:43] offset:5440
  ds_write_b128 v5, v[44:47] offset:5504
  ds_write_b128 v5, v[48:51] offset:5568
  ds_write_b128 v5, v[52:55] offset:5632
  ds_write_b128 v5, v[56:59] offset:10752
  ds_write_b128 v5, v[60:63] offset:10816
  ds_write_b128 v5, v[64:67] offset:10880
  ds_write_b128 v5, v[68:71] offset:10944
  ds_write_b128 v5, v[72:75] offset:11008
  ds_write_b128 v5, v[76:79] offset:16128
  ds_write_b128 v5, v[80:83] offset:16192
  ds_write_b128 v5, v[84:87] offset:16256
  ds_write_b128 v5, v[88:91] offset:16320
  ds_write_b128 v5, v[92:95] offset:16384
  s_waitcnt lgkmcnt(0)
  s_branch L4_fin
L4_loader:
  s_sub_u32 s27, s26, 4
  s_lshr_b32 s28, s27, 1
  s_and_b32 s27, s27, 1
  s_mul_i32 s34, s28, 36864
  s_mul_i32 s32, s28, 57344
  s_mul_i32 s33, s28, 71680
  v_lshlrev_b32 v8, 4, v0
  s_cmp_eq_u32 s27, 1
  s_cbranch_scc1 L4_ld1
  s_add_u32 s35, s34, 0
  s_mov_b32 m0, s35
  s_add_u32 s35, s35, 8192
  buffer_load_dwordx4 v8, s[8:11], s32 offen offset:0 lds
  buffer_load_dwordx4 v8, s[8:11], s32 offen offset:1024 lds
  buffer_load_dwordx4 v8, s[8:11], s32 offen offset:2048 lds
  buffer_load_dwordx4 v8, s[8:11], s32 offen offset:3072 lds
  s_mov_b32 m0, s35
  s_add_u32 s32, s32, 4096
  s_add_u32 s35, s33, 4096
  buffer_load_dwordx4 v8, s[12:15], s35 offen lds
  s_add_u32 s33, s33, 5120
  s_add_u32 s35, s34, 9216
  s_mov_b32 m0, s35
  s_add_u32 s35, s35, 8192
  buffer_load_dwordx4 v8, s[8:11], s32 offen offset:0 lds
  buffer_load_dwordx4 v8, s[8:11], s32 offen offset:1024 lds
  buffer_load_dwordx4 v8, s[8:11], s32 offen offset:2048 lds
  buffer_load_dwordx4 v8, s[8:11], s32 offen offset:3072 lds
  s_mov_b32 m0, s35
  s_add_u32 s32, s32, 4096
  s_add_u32 s35, s33, 4096
  buffer_load_dwordx4 v8, s[12:15], s35 offen lds
  s_add_u32 s33, s33, 5120
  s_add_u32 s35, s34, 18432
  s_mov_b32 m0, s35
  s_add_u32 s35, s35, 8192
  buffer_load_dwordx4 v8, s[8:11], s32 offen offset:0 lds
  buffer_load_dwordx4 v8, s[8:11], s32 offen offset:1024 lds
  buffer_load_dwordx4 v8, s[8:11], s32 offen offset:2048 lds
  buffer_load_dwordx4 v8, s[8:11], s32 offen offset:3072 lds
  s_mov_b32 m0, s35
  s_add_u32 s32, s32, 4096
  s_add_u32 s35, s33, 4096
  buffer_load_dwordx4 v8, s[12:15], s35 offen lds
  s_add_u32 s33, s33, 5120
  s_add_u32 s35, s34, 27648
  s_mov_b32 m0, s35
  s_add_u32 s35, s35, 8192
  buffer_load_dwordx4 v8, s[8:11], s32 offen offset:0 lds
  buffer_load_dwordx4 v8, s[8:11], s32 offen offset:1024 lds
  buffer_load_dwordx4 v8, s[8:11], s32 offen offset:2048 lds
  buffer_load_dwordx4 v8, s[8:11], s32 offen offset:3072 lds
  s_mov_b32 m0, s35
  s_add_u32 s32, s32, 4096
  s_add_u32 s35, s33, 4096
  buffer_load_dwordx4 v8, s[12:15], s35 offen lds
  s_add_u32 s33, s33, 5120

L4_PFRET:
  s_mov_b64 exec, -1
  s_waitcnt vmcnt(15)
  s_barrier
  s_waitcnt vmcnt(10)
  s_barrier
  s_add_u32 s35, s34, 0
  s_mov_b32 m0, s35
  s_add_u32 s35, s35, 8192
  buffer_load_dwordx4 v8, s[8:11], s32 offen offset:0 lds
  buffer_load_dwordx4 v8, s[8:11], s32 offen offset:1024 lds
  buffer_load_dwordx4 v8, s[8:11], s32 offen offset:2048 lds
  buffer_load_dwordx4 v8, s[8:11], s32 offen offset:3072 lds
  s_mov_b32 m0, s35
  s_add_u32 s32, s32, 4096
  s_add_u32 s35, s33, 4096
  buffer_load_dwordx4 v8, s[12:15], s35 offen lds
  s_add_u32 s33, s33, 5120
  s_waitcnt vmcnt(10)
  s_barrier
  s_add_u32 s35, s34, 9216
  s_mov_b32 m0, s35
  s_add_u32 s35, s35, 8192
  buffer_load_dwordx4 v8, s[8:11], s32 offen offset:0 lds
  buffer_load_dwordx4 v8, s[8:11], s32 offen offset:1024 lds
  buffer_load_dwordx4 v8, s[8:11], s32 offen offset:2048 lds
  buffer_load_dwordx4 v8, s[8:11], s32 offen offset:3072 lds
  s_mov_b32 m0, s35
  s_add_u32 s32, s32, 4096
  s_add_u32 s35, s33, 4096
  buffer_load_dwordx4 v8, s[12:15], s35 offen lds
  s_add_u32 s33, s33, 5120
  s_waitcnt vmcnt(10)
  s_barrier
  s_add_u32 s35, s34, 18432
  s_mov_b32 m0, s35
  s_add_u32 s35, s35, 8192
  buffer_load_dwordx4 v8, s[8:11], s32 offen offset:0 lds
  buffer_load_dwordx4 v8, s[8:11], s32 offen offset:1024 lds
  buffer_load_dwordx4 v8, s[8:11], s32 offen offset:2048 lds
  buffer_load_dwordx4 v8, s[8:11], s32 offen offset:3072 lds
  s_mov_b32 m0, s35
  s_add_u32 s32, s32, 4096
  s_add_u32 s35, s33, 4096
  buffer_load_dwordx4 v8, s[12:15], s35 offen lds
  s_add_u32 s33, s33, 5120
  s_waitcnt vmcnt(10)
  s_barrier
  s_add_u32 s35, s34, 27648
  s_mov_b32 m0, s35
  s_add_u32 s35, s35, 8192
  buffer_load_dwordx4 v8, s[8:11], s32 offen offset:0 lds
  buffer_load_dwordx4 v8, s[8:11], s32 offen offset:1024 lds
  buffer_load_dwordx4 v8, s[8:11], s32 offen offset:2048 lds
  buffer_load_dwordx4 v8, s[8:11], s32 offen offset:3072 lds
  s_mov_b32 m0, s35
  s_add_u32 s32, s32, 4096
  s_add_u32 s35, s33, 4096
  buffer_load_dwordx4 v8, s[12:15], s35 offen lds
  s_add_u32 s33, s33, 5120
  s_waitcnt vmcnt(10)
  s_barrier
  s_add_u32 s35, s34, 0
  s_mov_b32 m0, s35
  s_add_u32 s35, s35, 8192
  buffer_load_dwordx4 v8, s[8:11], s32 offen offset:0 lds
  buffer_load_dwordx4 v8, s[8:11], s32 offen offset:1024 lds
  buffer_load_dwordx4 v8, s[8:11], s32 offen offset:2048 lds
  buffer_load_dwordx4 v8, s[8:11], s32 offen offset:3072 lds
  s_mov_b32 m0, s35
  s_add_u32 s32, s32, 4096
  s_add_u32 s35, s33, 4096
  buffer_load_dwordx4 v8, s[12:15], s35 offen lds
  s_add_u32 s33, s33, 5120
  s_waitcnt vmcnt(10)
  s_barrier
  s_add_u32 s35, s34, 9216
  s_mov_b32 m0, s35
  s_add_u32 s35, s35, 8192
  buffer_load_dwordx4 v8, s[8:11], s32 offen offset:0 lds
  buffer_load_dwordx4 v8, s[8:11], s32 offen offset:1024 lds
  buffer_load_dwordx4 v8, s[8:11], s32 offen offset:2048 lds
  buffer_load_dwordx4 v8, s[8:11], s32 offen offset:3072 lds
  s_mov_b32 m0, s35
  s_add_u32 s32, s32, 4096
  s_add_u32 s35, s33, 4096
  buffer_load_dwordx4 v8, s[12:15], s35 offen lds
  s_add_u32 s33, s33, 5120
  s_waitcnt vmcnt(10)
  s_barrier
  s_add_u32 s35, s34, 18432
  s_mov_b32 m0, s35
  s_add_u32 s35, s35, 8192
  buffer_load_dwordx4 v8, s[8:11], s32 offen offset:0 lds
  buffer_load_dwordx4 v8, s[8:11], s32 offen offset:1024 lds
  buffer_load_dwordx4 v8, s[8:11], s32 offen offset:2048 lds
  buffer_load_dwordx4 v8, s[8:11], s32 offen offset:3072 lds
  s_mov_b32 m0, s35
  s_add_u32 s32, s32, 4096
  s_add_u32 s35, s33, 4096
  buffer_load_dwordx4 v8, s[12:15], s35 offen lds
  s_add_u32 s33, s33, 5120
  s_waitcnt vmcnt(10)
  s_barrier
  s_add_u32 s35, s34, 27648
  s_mov_b32 m0, s35
  s_add_u32 s35, s35, 8192
  buffer_load_dwordx4 v8, s[8:11], s32 offen offset:0 lds
  buffer_load_dwordx4 v8, s[8:11], s32 offen offset:1024 lds
  buffer_load_dwordx4 v8, s[8:11], s32 offen offset:2048 lds
  buffer_load_dwordx4 v8, s[8:11], s32 offen offset:3072 lds
  s_mov_b32 m0, s35
  s_add_u32 s32, s32, 4096
  s_add_u32 s35, s33, 4096
  buffer_load_dwordx4 v8, s[12:15], s35 offen lds
  s_add_u32 s33, s33, 5120
  s_waitcnt vmcnt(10)
  s_barrier
  s_add_u32 s35, s34, 0
  s_mov_b32 m0, s35
  s_add_u32 s35, s35, 8192
  buffer_load_dwordx4 v8, s[8:11], s32 offen offset:0 lds
  buffer_load_dwordx4 v8, s[8:11], s32 offen offset:1024 lds
  buffer_load_dwordx4 v8, s[8:11], s32 offen offset:2048 lds
  buffer_load_dwordx4 v8, s[8:11], s32 offen offset:3072 lds
  s_mov_b32 m0, s35
  s_add_u32 s32, s32, 4096
  s_add_u32 s35, s33, 4096
  buffer_load_dwordx4 v8, s[12:15], s35 offen lds
  s_add_u32 s33, s33, 5120
  s_waitcnt vmcnt(10)
  s_barrier
  s_add_u32 s35, s34, 9216
  s_mov_b32 m0, s35
  s_add_u32 s35, s35, 8192
  buffer_load_dwordx4 v8, s[8:11], s32 offen offset:0 lds
  buffer_load_dwordx4 v8, s[8:11], s32 offen offset:1024 lds
  buffer_load_dwordx4 v8, s[8:11], s32 offen offset:2048 lds
  buffer_load_dwordx4 v8, s[8:11], s32 offen offset:3072 lds
  s_mov_b32 m0, s35
  s_add_u32 s32, s32, 4096
  s_add_u32 s35, s33, 4096
  buffer_load_dwordx4 v8, s[12:15], s35 offen lds
  s_add_u32 s33, s33, 5120
  s_waitcnt vmcnt(10)
  s_barrier
  s_waitcnt vmcnt(5)
  s_barrier
  s_waitcnt vmcnt(0)
  s_barrier
  s_branch L4_fin
L4_ld1:
  s_add_u32 s35, s34, 4096
  s_mov_b32 m0, s35
  s_nop 0
  buffer_load_dwordx4 v8, s[12:15], s33 offen offset:0 lds
  buffer_load_dwordx4 v8, s[12:15], s33 offen offset:1024 lds
  buffer_load_dwordx4 v8, s[12:15], s33 offen offset:2048 lds
  buffer_load_dwordx4 v8, s[12:15], s33 offen offset:3072 lds
  s_add_u32 s33, s33, 5120
  s_add_u32 s35, s34, 13312
  s_mov_b32 m0, s35
  s_nop 0
  buffer_load_dwordx4 v8, s[12:15], s33 offen offset:0 lds
  buffer_load_dwordx4 v8, s[12:15], s33 offen offset:1024 lds
  buffer_load_dwordx4 v8, s[12:15], s33 offen offset:2048 lds
  buffer_load_dwordx4 v8, s[12:15], s33 offen offset:3072 lds
  s_add_u32 s33, s33, 5120
  s_add_u32 s35, s34, 22528
  s_mov_b32 m0, s35
  s_nop 0
  buffer_load_dwordx4 v8, s[12:15], s33 offen offset:0 lds
  buffer_load_dwordx4 v8, s[12:15], s33 offen offset:1024 lds
  buffer_load_dwordx4 v8, s[12:15], s33 offen offset:2048 lds
  buffer_load_dwordx4 v8, s[12:15], s33 offen offset:3072 lds
  s_add_u32 s33, s33, 5120
  s_add_u32 s35, s34, 31744
  s_mov_b32 m0, s35
  s_nop 0
  buffer_load_dwordx4 v8, s[12:15], s33 offen offset:0 lds
  buffer_load_dwordx4 v8, s[12:15], s33 offen offset:1024 lds
  buffer_load_dwordx4 v8, s[12:15], s33 offen offset:2048 lds
  buffer_load_dwordx4 v8, s[12:15], s33 offen offset:3072 lds
  s_add_u32 s33, s33, 5120
  s_waitcnt vmcnt(12)
  s_barrier
  s_waitcnt vmcnt(8)
  s_barrier
  s_add_u32 s35, s34, 4096
  s_mov_b32 m0, s35
  s_nop 0
  buffer_load_dwordx4 v8, s[12:15], s33 offen offset:0 lds
  buffer_load_dwordx4 v8, s[12:15], s33 offen offset:1024 lds
  buffer_load_dwordx4 v8, s[12:15], s33 offen offset:2048 lds
  buffer_load_dwordx4 v8, s[12:15], s33 offen offset:3072 lds
  s_add_u32 s33, s33, 5120
  s_waitcnt vmcnt(8)
  s_barrier
  s_add_u32 s35, s34, 13312
  s_mov_b32 m0, s35
  s_nop 0
  buffer_load_dwordx4 v8, s[12:15], s33 offen offset:0 lds
  buffer_load_dwordx4 v8, s[12:15], s33 offen offset:1024 lds
  buffer_load_dwordx4 v8, s[12:15], s33 offen offset:2048 lds
  buffer_load_dwordx4 v8, s[12:15], s33 offen offset:3072 lds
  s_add_u32 s33, s33, 5120
  s_waitcnt vmcnt(8)
  s_barrier
  s_add_u32 s35, s34, 22528
  s_mov_b32 m0, s35
  s_nop 0
  buffer_load_dwordx4 v8, s[12:15], s33 offen offset:0 lds
  buffer_load_dwordx4 v8, s[12:15], s33 offen offset:1024 lds
  buffer_load_dwordx4 v8, s[12:15], s33 offen offset:2048 lds
  buffer_load_dwordx4 v8, s[12:15], s33 offen offset:3072 lds
  s_add_u32 s33, s33, 5120
  s_waitcnt vmcnt(8)
  s_barrier
  s_add_u32 s35, s34, 31744
  s_mov_b32 m0, s35
  s_nop 0
  buffer_load_dwordx4 v8, s[12:15], s33 offen offset:0 lds
  buffer_load_dwordx4 v8, s[12:15], s33 offen offset:1024 lds
  buffer_load_dwordx4 v8, s[12:15], s33 offen offset:2048 lds
  buffer_load_dwordx4 v8, s[12:15], s33 offen offset:3072 lds
  s_add_u32 s33, s33, 5120
  s_waitcnt vmcnt(8)
  s_barrier
  s_add_u32 s35, s34, 4096
  s_mov_b32 m0, s35
  s_nop 0
  buffer_load_dwordx4 v8, s[12:15], s33 offen offset:0 lds
  buffer_load_dwordx4 v8, s[12:15], s33 offen offset:1024 lds
  buffer_load_dwordx4 v8, s[12:15], s33 offen offset:2048 lds
  buffer_load_dwordx4 v8, s[12:15], s33 offen offset:3072 lds
  s_add_u32 s33, s33, 5120
  s_waitcnt vmcnt(8)
  s_barrier
  s_add_u32 s35, s34, 13312
  s_mov_b32 m0, s35
  s_nop 0
  buffer_load_dwordx4 v8, s[12:15], s33 offen offset:0 lds
  buffer_load_dwordx4 v8, s[12:15], s33 offen offset:1024 lds
  buffer_load_dwordx4 v8, s[12:15], s33 offen offset:2048 lds
  buffer_load_dwordx4 v8, s[12:15], s33 offen offset:3072 lds
  s_add_u32 s33, s33, 5120
  s_waitcnt vmcnt(8)
  s_barrier
  s_add_u32 s35, s34, 22528
  s_mov_b32 m0, s35
  s_nop 0
  buffer_load_dwordx4 v8, s[12:15], s33 offen offset:0 lds
  buffer_load_dwordx4 v8, s[12:15], s33 offen offset:1024 lds
  buffer_load_dwordx4 v8, s[12:15], s33 offen offset:2048 lds
  buffer_load_dwordx4 v8, s[12:15], s33 offen offset:3072 lds
  s_add_u32 s33, s33, 5120
  s_waitcnt vmcnt(8)
  s_barrier
  s_add_u32 s35, s34, 31744
  s_mov_b32 m0, s35
  s_nop 0
  buffer_load_dwordx4 v8, s[12:15], s33 offen offset:0 lds
  buffer_load_dwordx4 v8, s[12:15], s33 offen offset:1024 lds
  buffer_load_dwordx4 v8, s[12:15], s33 offen offset:2048 lds
  buffer_load_dwordx4 v8, s[12:15], s33 offen offset:3072 lds
  s_add_u32 s33, s33, 5120
  s_waitcnt vmcnt(8)
  s_barrier
  s_add_u32 s35, s34, 4096
  s_mov_b32 m0, s35
  s_nop 0
  buffer_load_dwordx4 v8, s[12:15], s33 offen offset:0 lds
  buffer_load_dwordx4 v8, s[12:15], s33 offen offset:1024 lds
  buffer_load_dwordx4 v8, s[12:15], s33 offen offset:2048 lds
  buffer_load_dwordx4 v8, s[12:15], s33 offen offset:3072 lds
  s_add_u32 s33, s33, 5120
  s_waitcnt vmcnt(8)
  s_barrier
  s_add_u32 s35, s34, 13312
  s_mov_b32 m0, s35
  s_nop 0
  buffer_load_dwordx4 v8, s[12:15], s33 offen offset:0 lds
  buffer_load_dwordx4 v8, s[12:15], s33 offen offset:1024 lds
  buffer_load_dwordx4 v8, s[12:15], s33 offen offset:2048 lds
  buffer_load_dwordx4 v8, s[12:15], s33 offen offset:3072 lds
  s_add_u32 s33, s33, 5120
  s_waitcnt vmcnt(8)
  s_barrier
  s_waitcnt vmcnt(4)
  s_barrier
  s_waitcnt vmcnt(0)
  s_barrier
  s_branch L4_fin
L4_fin:
  s_barrier
  v_add_u32 v3, 0, v2
  v_min_u32 v3, 639, v3
  s_movk_i32 s41, 6554
  v_mul_u32_u24 v4, s41, v3
  v_lshrrev_b32 v4, 16, v4
  v_mul_u32_u24 v6, 10, v4
  v_sub_u32 v5, v3, v6
  v_mul_u32_u24 v6, 336, v4
  v_lshl_add_u32 v6, v5, 5, v6
  v_add_u32 v3, 73728, v6
  ds_read_b128 v[24:27], v6 offset:0
  ds_read_b128 v[28:31], v6 offset:16
  ds_read_b128 v[32:35], v6 offset:36864
  ds_read_b128 v[36:39], v6 offset:36880
  ds_read_b128 v[40:43], v3 offset:0
  ds_read_b128 v[44:47], v3 offset:16
  ds_read_b128 v[48:51], v3 offset:36864
  ds_read_b128 v[52:55], v3 offset:36880
  s_waitcnt lgkmcnt(0)
  v_pk_add_f32 v[24:25], v[24:25], v[32:33]
  v_pk_add_f32 v[40:41], v[40:41], v[48:49]
  v_pk_add_f32 v[26:27], v[26:27], v[34:35]
  v_pk_add_f32 v[42:43], v[42:43], v[50:51]
  v_pk_add_f32 v[28:29], v[28:29], v[36:37]
  v_pk_add_f32 v[44:45], v[44:45], v[52:53]
  v_pk_add_f32 v[30:31], v[30:31], v[38:39]
  v_pk_add_f32 v[46:47], v[46:47], v[54:55]
  v_pk_add_f32 v[24:25], v[24:25], v[40:41]
  v_pk_add_f32 v[26:27], v[26:27], v[42:43]
  v_pk_add_f32 v[28:29], v[28:29], v[44:45]
  v_pk_add_f32 v[30:31], v[30:31], v[46:47]
  s_waitcnt vmcnt(0)
  v_lshlrev_b32 v32, 16, v12
  v_and_b32 v33, 0xffff0000, v12
  v_pk_add_f32 v[24:25], v[24:25], v[32:33]
  v_cvt_pk_bf16_f32 v36, v24, v25
  v_lshlrev_b32 v32, 16, v13
  v_and_b32 v33, 0xffff0000, v13
  v_pk_add_f32 v[26:27], v[26:27], v[32:33]
  v_cvt_pk_bf16_f32 v37, v26, v27
  v_lshlrev_b32 v32, 16, v14
  v_and_b32 v33, 0xffff0000, v14
  v_pk_add_f32 v[28:29], v[28:29], v[32:33]
  v_cvt_pk_bf16_f32 v38, v28, v29
  v_lshlrev_b32 v32, 16, v15
  v_and_b32 v33, 0xffff0000, v15
  v_pk_add_f32 v[30:31], v[30:31], v[32:33]
  v_cvt_pk_bf16_f32 v39, v30, v31
  buffer_store_dwordx4 v[36:39], v10, s[20:23], 0 offen
L4_done:
  s_endpgm
Lcode_end:
.section .rodata,"a"
.p2align 6
.amdhsa_kernel k1_qkv_kernel
  .amdhsa_next_free_vgpr 168
  .amdhsa_next_free_sgpr 96
  .amdhsa_accum_offset 168
  .amdhsa_group_segment_fixed_size 0
  .amdhsa_kernarg_size 72
  .amdhsa_user_sgpr_count 2
  .amdhsa_user_sgpr_kernarg_segment_ptr 1
  .amdhsa_system_sgpr_workgroup_id_x 1
.end_amdhsa_kernel
.p2align 6
.amdhsa_kernel k2_attn_kernel
  .amdhsa_next_free_vgpr 256
  .amdhsa_next_free_sgpr 96
  .amdhsa_accum_offset 256
  .amdhsa_group_segment_fixed_size 0
  .amdhsa_kernarg_size 72
  .amdhsa_user_sgpr_count 2
  .amdhsa_user_sgpr_kernarg_segment_ptr 1
  .amdhsa_system_sgpr_workgroup_id_x 1
.end_amdhsa_kernel
.p2align 6
.amdhsa_kernel k3_ffn1_kernel
  .amdhsa_next_free_vgpr 168
  .amdhsa_next_free_sgpr 96
  .amdhsa_accum_offset 168
  .amdhsa_group_segment_fixed_size 0
  .amdhsa_kernarg_size 72
  .amdhsa_user_sgpr_count 2
  .amdhsa_user_sgpr_kernarg_segment_ptr 1
  .amdhsa_system_sgpr_workgroup_id_x 1
.end_amdhsa_kernel
.p2align 6
.amdhsa_kernel k4_ffn2_kernel
  .amdhsa_next_free_vgpr 168
  .amdhsa_next_free_sgpr 96
  .amdhsa_accum_offset 168
  .amdhsa_group_segment_fixed_size 0
  .amdhsa_kernarg_size 72
  .amdhsa_user_sgpr_count 2
  .amdhsa_user_sgpr_kernarg_segment_ptr 1
  .amdhsa_system_sgpr_workgroup_id_x 1
.end_amdhsa_kernel
```
